```python
import torch

def _softmax(x, axis=-1):
    return torch.softmax(x, dim=axis)

def _gelu(x):
    return torch.nn.functional.gelu(x, approximate='tanh')

def _silu(x):
    return torch.nn.functional.silu(x)

def _sigmoid(x):
    return torch.sigmoid(x)

def _layernorm(x, axis=-1, eps=1e-05):
    m = x.mean(dim=axis, keepdim=True)
    v = x.var(dim=axis, keepdim=True, unbiased=False)
    return (x - m) / torch.sqrt(v + eps)

def _scatter_add(tgt, idx, src, axis=0):
    return tgt.clone().index_add_(axis, idx, src)

def _segment_sum(src, seg, n):
    out = torch.zeros((n,) + src.shape[1:], dtype=src.dtype)
    return out.index_add_(0, seg, src)

def _pad(x, pw):
    flat = tuple((v for pair in reversed(pw) for v in pair))
    return torch.nn.functional.pad(x, flat)
kernel_name = 'adaLN_cond__sliding_block_cached__glu_gated_reglu__decode'

def setup_inputs():

    _w = lambda a: (lambda t: t.to(torch.bfloat16) if t.is_floating_point() else t)(torch.as_tensor(a))

    def _A_setup():
        B, Sq, D = (4, 1, 640)
        Hq, Hkv, Sk, Dh = (32, 32, 4096, 192)
        assert Hq % Hkv == 0, (Hq, Hkv)
        return {'x': _w((lambda *s: torch.randn(*s, dtype=torch.bfloat16) * 0.1)(B, Sq, D)), 'k_cache': _w((lambda *s: torch.randn(*s, dtype=torch.bfloat16) * 0.8)(B, Hkv, Sk, Dh)), 'v_cache': _w((lambda *s: torch.randn(*s, dtype=torch.bfloat16) * 3.2)(B, Hkv, Sk, Dh)), 'wq': _w((lambda *s: torch.randn(*s, dtype=torch.bfloat16) * 0.8)(D, Hq * Dh) * D ** (-0.5)), 'wo': _w((lambda *s: torch.randn(*s, dtype=torch.bfloat16) * 3.2)(Hq * Dh, D) * (Hq * Dh) ** (-0.5))}
    _A_in = _A_setup()

    def _B_setup():
        B, S, D, F = (4, 1, 640, 1536)
        return {'x': _w((lambda *s: torch.randn(*s, dtype=torch.bfloat16) * 0.1)(B, S, D)), 'W_gate': _w((lambda *s: torch.randn(*s, dtype=torch.bfloat16) * 3.2)(D, F) * (2.0 / D) ** 0.5), 'W_up': _w((lambda *s: torch.randn(*s, dtype=torch.bfloat16) * 3.2)(D, F) * (2.0 / D) ** 0.5), 'W_down': _w((lambda *s: torch.randn(*s, dtype=torch.bfloat16) * 3.2)(F, D) * (1.0 / F) ** 0.5)}
    _B_in = _B_setup()
    return {'A_x': _A_in['x'], 'A_k_cache': _A_in['k_cache'], 'A_v_cache': _A_in['v_cache'], 'A_wq': _A_in['wq'], 'A_wo': _A_in['wo'], 'B_x': _B_in['x'], 'B_W_gate': _B_in['W_gate'], 'B_W_up': _B_in['W_up'], 'B_W_down': _B_in['W_down'], 'c': _w((lambda *s: torch.randn(*s, dtype=torch.bfloat16) * 0.4)(4, 640) * 8.0), 'w_mod': _w((lambda *s: torch.randn(*s, dtype=torch.bfloat16) * 0.4)(640, 6 * 640) * 640 ** (-0.5) * 8.0)}

def reference(A_x, A_k_cache, A_v_cache, A_wq, A_wo, B_x, B_W_gate, B_W_up, B_W_down, c, w_mod):

    def _A_ref(x, k_cache, v_cache, wq, wo):
        B, Sq, D = x.shape
        Hq, Dh = (32, 192)
        Hkv, Sk = (k_cache.shape[1], k_cache.shape[2])
        W = min(4096, max(256, Sk // 4))
        rep = Hq // Hkv
        q = (lambda x, *d: x.permute(*d))((x @ wq).reshape(B, Sq, Hq, Dh), 0, 2, 1, 3)
        k = (lambda x, n, axis: torch.repeat_interleave(x, n, dim=axis))(k_cache[:, :, Sk - W:, :], rep, axis=1)
        v = (lambda x, n, axis: torch.repeat_interleave(x, n, dim=axis))(v_cache[:, :, Sk - W:, :], rep, axis=1)
        scores = torch.einsum('bhqd,bhkd->bhqk', q, k) * Dh ** (-0.5)
        p = _softmax(scores, axis=-1)
        o = torch.einsum('bhqk,bhkd->bhqd', p, v)
        return (lambda x, *d: x.permute(*d))(o, 0, 2, 1, 3).reshape(B, Sq, Hq * Dh) @ wo

    def _B_ref(x, W_gate, W_up, W_down):
        gate = torch.einsum('bsd,df->bsf', x, W_gate)
        up = torch.einsum('bsd,df->bsf', x, W_up)
        gate = gate * (lambda x, dt: x.to(dt))(gate > 0, gate.dtype)
        h = gate * up
        return torch.einsum('bsf,fd->bsd', h, W_down)
    x = A_x
    mod = (_silu(c) @ w_mod).reshape(c.shape[0], 6, 1, -1)
    sa, ca, ga, sb, cb, gb = (mod[:, 0].clone(), mod[:, 1].clone(), mod[:, 2].clone(), mod[:, 3].clone(), mod[:, 4].clone(), mod[:, 5].clone())
    h = _layernorm(x, axis=-1) * (1 + ca) + sa
    x = x + ga * _A_ref(h, A_k_cache, A_v_cache, A_wq, A_wo)
    h = _layernorm(x, axis=-1) * (1 + cb) + sb
    x = x + gb * _B_ref(h, B_W_gate, B_W_up, B_W_down)
    return x
```

```asm
; @launch grid=(256,1,1) block=(512,1,1) lds=163840
.amdgcn_target "amdgcn-amd-amdhsa--gfx950"
.text
.globl adaLN_cond__sliding_block_cached__glu_gated_reglu__decode_kernel
.p2align 8
.type adaLN_cond__sliding_block_cached__glu_gated_reglu__decode_kernel,@function
adaLN_cond__sliding_block_cached__glu_gated_reglu__decode_kernel:
    s_cmp_ge_u32 s2, 256
    s_cbranch_scc1 L_exit
    s_load_dwordx16 s[16:31], s[0:1], 0
    s_load_dwordx8 s[32:39], s[0:1], 64
    s_load_dwordx4 s[40:43], s[0:1], 96
    v_and_b32 v1, 63, v0
    v_lshrrev_b32 v6, 6, v0
    s_nop 0
    v_readfirstlane_b32 s3, v6
    v_and_b32 v4, 15, v1
    v_lshrrev_b32 v5, 4, v1
    s_and_b32 s8, s2, 7
    s_lshr_b32 s9, s2, 3
    s_and_b32 s10, s9, 3
    s_lshl_b32 s4, s8, 2
    s_add_u32 s4, s4, s10
    s_lshr_b32 s5, s9, 2
    s_and_b32 s5, s5, 3
    s_lshr_b32 s6, s9, 4
    s_lshl_b32 s7, s5, 5
    s_add_u32 s7, s7, s4
    s_lshl_b32 s7, s7, 12
    s_add_u32 s7, s7, 3072
    s_lshl_b32 s10, s6, 9
    s_add_u32 s7, s7, s10
    s_lshl_b32 s10, s3, 3
    s_add_u32 s7, s7, s10
    s_mul_i32 s7, s7, 384
    s_mul_i32 s101, s8, 30
    s_add_u32 s101, s101, s9
    s_mul_i32 s10, s8, 10
    s_add_u32 s10, s10, s9
    s_sub_u32 s10, s10, 20
    s_sub_u32 s11, s101, 80
    s_cmp_lt_u32 s8, 4
    s_cselect_b32 s10, s10, s11
    s_cselect_b32 s12, 20, 0
    s_mul_i32 s88, s10, 1639
    s_lshr_b32 s88, s88, 16
    s_mul_i32 s11, s88, 40
    s_sub_u32 s89, s10, s11
    s_add_u32 s89, s89, 20
    s_cmp_lt_u32 s9, s12
    s_cselect_b32 s88, s8, s88
    s_cselect_b32 s89, s9, s89
    s_mul_i32 s90, s101, 1366
    s_lshr_b32 s90, s90, 16
    s_mul_i32 s10, s90, 48
    s_sub_u32 s91, s101, s10
    s_mul_i32 s99, s2, 3277
    s_lshr_b32 s99, s99, 16
    s_mul_i32 s10, s99, 20
    s_sub_u32 s100, s2, s10
    v_lshrrev_b32 v6, 1, v4
    v_mul_u32_u24 v6, 384, v6
    v_and_b32 v7, 1, v4
    v_lshl_add_u32 v7, v7, 2, v5
    v_lshl_add_u32 v2, v7, 4, v6
    v_lshrrev_b32 v8, 3, v1
    v_mul_u32_u24 v6, 384, v8
    v_and_b32 v7, 7, v1
    v_lshl_add_u32 v3, v7, 4, v6
    v_mul_u32_u24 v8, 7680, v8
    v_lshl_add_u32 v8, v7, 4, v8
    v_mul_u32_u24 v9, 12288, v5
    v_lshl_add_u32 v61, v4, 4, v9
    s_mov_b32 s72, 0xaaaaaaaa
    s_mov_b32 s73, 0xaaaaaaaa
    s_mov_b32 s74, 0xff00ff00
    s_mov_b32 s75, 0xff00ff00
    s_mov_b32 s76, 0xffff0000
    s_mov_b32 s77, 0
    s_mov_b32 s78, 0
    s_mov_b32 s79, 0x0000ffff
    s_mov_b32 s80, 0
    s_mov_b32 s81, 0xffff0000
    s_mov_b32 s82, 0x00ff00ff
    s_mov_b32 s83, 0xff00ff00
    s_mov_b32 s92, 0
    s_mov_b32 s93, -1
    s_mov_b32 s84, 100000
    s_mov_b32 s94, 0x07060503
    s_mov_b32 s95, 0x07060502
    s_mov_b32 s96, 0x07060501
    s_mov_b32 s97, 0x04000c0c
    s_mov_b32 s98, 0x0706000c
    s_mul_i32 s11, s88, 160
    s_lshl_b32 s12, s3, 3
    s_add_u32 s11, s11, s12
    s_mul_i32 s11, s11, 7680
    s_lshl_b32 s12, s89, 7
    s_add_u32 s11, s11, s12
    s_lshl_b32 s12, s3, 10
    s_lshl_b32 s13, s90, 7
    s_lshl_b32 s14, s3, 4
    s_add_u32 s13, s13, s14
    s_mul_i32 s13, s13, 12288
    s_lshl_b32 s14, s91, 8
    s_add_u32 s13, s13, s14
    s_lshl_b32 s14, s3, 12
    s_add_u32 s14, s14, 20480
    s_waitcnt lgkmcnt(0)
    s_load_dword s85, s[42:43], 0
    s_mov_b32 s56, s36
    s_mov_b32 s57, s37
    s_mov_b32 s58, 4915200
    s_mov_b32 s59, 0x20000
    s_mov_b32 s60, s22
    s_mov_b32 s61, s23
    s_mov_b32 s62, 7864320
    s_mov_b32 s63, 0x20000
    s_mov_b32 s52, s42
    s_mov_b32 s53, s43
    s_mov_b32 s54, 6160384
    s_mov_b32 s55, 0x20000
    s_mov_b32 s44, s18
    s_mov_b32 s45, s19
    s_mov_b32 s46, 201326592
    s_mov_b32 s47, 0x20000
    s_mov_b32 s48, s20
    s_mov_b32 s49, s21
    s_mov_b32 s50, 201326592
    s_mov_b32 s51, 0x20000
    s_cmp_eq_u32 s3, 0
    s_cbranch_scc0 L_p_dma
    s_mov_b32 s64, s34
    s_mov_b32 s65, s35
    s_mov_b32 s66, 5120
    s_mov_b32 s67, 0x20000
    v_mov_b32 v10, 156352
    v_mov_b32 v12, 0
    v_mov_b32 v13, 0
    ds_write_b64 v10, v[12:13]
    ds_write_b64 v10, v[12:13] offset:8
    ds_write_b64 v10, v[12:13] offset:16
    ds_write_b64 v10, v[12:13] offset:24
    ds_write_b64 v10, v[12:13] offset:32
    ds_write_b64 v10, v[12:13] offset:40
    ds_write_b64 v10, v[12:13] offset:48
    v_and_b32 v6, 3, v4
    v_mul_u32_u24 v11, 1280, v6
    v_lshl_add_u32 v11, v5, 4, v11
    s_mul_i32 s10, s88, 320
    v_mul_u32_u24 v14, 1280, v5
    v_mul_u32_u24 v15, 20, v4
    v_add_u32 v14, v14, v15
    buffer_load_dwordx4 v[204:207], v14, s[64:67], s10 offen
    buffer_load_dword v55, v14, s[64:67], s10 offen offset:16
    s_mov_b32 s64, s16
    s_mov_b32 s65, s17
    s_mov_b32 s66, 5120
    s_mov_b32 s67, 0x20000
    v_lshrrev_b32 v7, 2, v4
    v_mul_u32_u24 v16, 320, v7
    v_add_u32 v16, v16, v11
    v_mul_u32_u24 v17, 1280, v6
    v_lshl_add_u32 v17, v7, 5, v17
    v_lshl_add_u32 v17, v5, 3, v17
    s_lshl_b32 s10, s90, 8
    buffer_load_dwordx4 v[128:131], v16, s[64:67], 0 offen offset:0
    buffer_load_dwordx4 v[132:135], v16, s[64:67], 0 offen offset:64
    buffer_load_dwordx4 v[136:139], v16, s[64:67], 0 offen offset:128
    buffer_load_dwordx4 v[140:143], v16, s[64:67], 0 offen offset:192
    buffer_load_dwordx4 v[144:147], v16, s[64:67], 0 offen offset:256
    buffer_load_dwordx2 v[148:149], v17, s[64:67], s10 offen
    buffer_load_dwordx2 v[150:151], v17, s[64:67], s10 offen offset:128
    v_mul_u32_u24 v16, 1280, v5
    v_lshl_add_u32 v16, v4, 2, v16
    s_lshl_b32 s10, s100, 6
    buffer_load_dword v52, v16, s[64:67], s10 offen
L_p_dma:
    s_cmp_ge_u32 s2, 240
    s_cbranch_scc1 L_p_nodma
    s_add_u32 m0, s12, 0
    s_nop 0
    buffer_load_dwordx4 v8, s[56:59], s11 offen nt lds
    s_add_u32 s11, s11, 491520
    s_add_u32 m0, s12, 8192
    s_nop 0
    buffer_load_dwordx4 v8, s[56:59], s11 offen nt lds
    s_add_u32 s11, s11, 491520
    s_cmp_ge_u32 s3, 4
    s_cbranch_scc1 L_p_wq
    s_add_u32 m0, s12, 16384
    s_nop 0
    buffer_load_dwordx4 v8, s[56:59], s11 offen nt lds
L_p_wq:
    s_add_u32 m0, s14, 0
    s_nop 0
    buffer_load_dwordx4 v61, s[60:63], s13 offen nt lds
    s_add_u32 s13, s13, 49152
    s_add_u32 m0, s14, 1024
    s_nop 0
    buffer_load_dwordx4 v61, s[60:63], s13 offen nt lds
    s_add_u32 s13, s13, 49152
    s_branch L_p_dmadone
L_p_nodma:
    s_mov_b32 s13, 0x10000000
L_p_dmadone:
    s_cmp_eq_u32 s3, 0
    s_cbranch_scc1 L_helper
    s_barrier
    v_mov_b32 v10, 156352
    v_mov_b32 v11, 1
    s_waitcnt vmcnt(2)
    s_mov_b32 exec_lo, 0x1
    s_mov_b32 exec_hi, 0x0
    ds_add_u32 v10, v11
    s_mov_b64 exec, -1
    s_add_u32 m0, s14, 2048
    s_nop 0
    buffer_load_dwordx4 v61, s[60:63], s13 offen nt lds
    s_add_u32 s13, s13, 49152
    s_waitcnt vmcnt(2)
    s_add_u32 m0, s14, 3072
    s_nop 0
    buffer_load_dwordx4 v61, s[60:63], s13 offen nt lds
    s_add_u32 s13, s13, 49152
    s_lshr_b32 s13, s2, 3
    s_add_u32 s13, s13, s2
    s_setprio 2
    s_add_u32 s8, s13, 0
    s_and_b32 s8, s8, 7
    s_mul_i32 s8, s8, 24576
    s_add_u32 s8, s8, s7
    s_waitcnt vmcnt(2)
    buffer_load_dwordx4 v[64:67], v2, s[44:47], s8 offen offset:0 nt
    s_waitcnt vmcnt(2)
    buffer_load_dwordx4 v[68:71], v2, s[44:47], s8 offen offset:128 nt
    s_waitcnt vmcnt(2)
    s_mov_b32 exec_lo, 0x1
    s_mov_b32 exec_hi, 0x0
    ds_add_u32 v10, v11 offset:4
    s_mov_b64 exec, -1
    buffer_load_dwordx4 v[72:75], v2, s[44:47], s8 offen offset:256 nt
    s_waitcnt lgkmcnt(0)
    s_add_u32 s85, s85, 1
    s_cmp_gt_u32 s3, 4
    s_cselect_b32 s9, 2, 1
    s_sub_u32 s9, s3, s9
    s_lshl_b32 s9, s9, 2
    s_mul_i32 s10, s3, 3072
    s_sub_u32 s10, s7, s10
    s_add_u32 s11, s9, 0
    s_mul_i32 s12, s11, 171
    s_lshr_b32 s12, s12, 9
    s_mul_i32 s26, s12, 24192
    s_lshl_b32 s27, s11, 7
    s_add_u32 s26, s26, s27
    s_add_u32 s26, s26, s10
    s_lshl_b32 s27, s11, 10
    s_add_u32 s15, s27, 73728
    s_add_u32 s27, s27, 98304
    s_cmp_eq_u32 s3, 4
    s_cselect_b32 s16, 0x10000000, s26
    s_cselect_b32 s20, 160768, s15
    s_cselect_b32 s64, 160768, s27
    s_add_u32 s11, s9, 1
    s_mul_i32 s12, s11, 171
    s_lshr_b32 s12, s12, 9
    s_mul_i32 s26, s12, 24192
    s_lshl_b32 s27, s11, 7
    s_add_u32 s26, s26, s27
    s_add_u32 s26, s26, s10
    s_lshl_b32 s27, s11, 10
    s_add_u32 s15, s27, 73728
    s_add_u32 s27, s27, 98304
    s_cmp_eq_u32 s3, 4
    s_cselect_b32 s17, 0x10000000, s26
    s_cselect_b32 s21, 160768, s15
    s_cselect_b32 s65, 160768, s27
    s_add_u32 s11, s9, 2
    s_mul_i32 s12, s11, 171
    s_lshr_b32 s12, s12, 9
    s_mul_i32 s26, s12, 24192
    s_lshl_b32 s27, s11, 7
    s_add_u32 s26, s26, s27
    s_add_u32 s26, s26, s10
    s_lshl_b32 s27, s11, 10
    s_add_u32 s15, s27, 73728
    s_add_u32 s27, s27, 98304
    s_cmp_eq_u32 s3, 4
    s_cselect_b32 s18, 0x10000000, s26
    s_cselect_b32 s22, 160768, s15
    s_cselect_b32 s66, 160768, s27
    s_add_u32 s11, s9, 3
    s_mul_i32 s12, s11, 171
    s_lshr_b32 s12, s12, 9
    s_mul_i32 s26, s12, 24192
    s_lshl_b32 s27, s11, 7
    s_add_u32 s26, s26, s27
    s_add_u32 s26, s26, s10
    s_lshl_b32 s27, s11, 10
    s_add_u32 s15, s27, 73728
    s_add_u32 s27, s27, 98304
    s_cmp_eq_u32 s3, 4
    s_cselect_b32 s19, 0x10000000, s26
    s_cselect_b32 s23, 160768, s15
    s_cselect_b32 s67, 160768, s27
    s_mul_i32 s9, s2, 6554
    s_lshr_b32 s9, s9, 16
    s_mul_i32 s10, s9, 10
    s_sub_u32 s10, s2, s10
    s_lshl_b32 s9, s9, 8
    s_and_b32 s12, s3, 3
    s_lshl_b32 s11, s12, 6
    s_add_u32 s9, s9, s11
    s_mul_i32 s9, s9, 1280
    s_lshl_b32 s10, s10, 7
    s_add_u32 s68, s9, s10
    v_lshrrev_b32 v59, 3, v1
    v_mul_u32_u24 v59, 1280, v59
    v_and_b32 v60, 7, v1
    v_lshl_add_u32 v59, v60, 4, v59
    v_mul_u32_u24 v60, 3072, v5
    v_lshl_add_u32 v60, v4, 4, v60
    v_lshlrev_b32 v62, 4, v1
    s_lshl_b32 s9, s100, 5
    s_lshl_b32 s10, s12, 3
    s_add_u32 s9, s9, s10
    s_mul_i32 s9, s9, 3072
    s_lshl_b32 s10, s99, 8
    s_add_u32 s69, s9, s10
    s_sub_u32 s11, s2, 144
    s_mul_i32 s11, s11, 20480
    s_mul_i32 s71, s12, 5120
    s_add_u32 s70, s11, s71
    s_lshr_b32 s9, s2, 3
    s_lshl_b32 s9, s9, 7
    s_add_u32 s9, s9, 6078464
    s_add_u32 s34, s42, s9
    s_addc_u32 s35, s43, 0
    s_and_b32 s10, s2, 7
    s_lshl_b32 s10, s10, 2
    s_add_u32 s36, s9, s10
    s_lshl_b32 s37, s85, 8
    s_add_u32 s9, s37, 3
    v_mov_b32 v61, s9
    s_add_u32 s8, s13, 1
    s_and_b32 s8, s8, 7
    s_mul_i32 s8, s8, 24576
    s_add_u32 s8, s8, s7
    s_waitcnt vmcnt(2)
    buffer_load_dwordx4 v[76:79], v2, s[44:47], s8 offen offset:0 nt
    s_waitcnt vmcnt(2)
    buffer_load_dwordx4 v[80:83], v2, s[44:47], s8 offen offset:128 nt
    s_waitcnt vmcnt(2)
    buffer_load_dwordx4 v[84:87], v2, s[44:47], s8 offen offset:256 nt
    s_mov_b64 vcc, 0
    s_cbranch_vccnz L_fc_1
    ds_read_b32 v12, v10 offset:8
    s_waitcnt lgkmcnt(0)
    v_cmp_ne_u32 vcc, 0, v12
L_fc_1:
    s_add_u32 s8, s13, 2
    s_and_b32 s8, s8, 7
    s_mul_i32 s8, s8, 24576
    s_add_u32 s8, s8, s7
    s_cbranch_vccnz L_sk_2
    s_waitcnt vmcnt(2)
L_sk_2:
    s_waitcnt vmcnt(7)
    buffer_load_dwordx4 v[88:91], v2, s[44:47], s8 offen offset:0 nt
    s_cbranch_vccnz L_sk_3
    s_waitcnt vmcnt(2)
L_sk_3:
    s_waitcnt vmcnt(7)
    buffer_load_dwordx4 v[92:95], v2, s[44:47], s8 offen offset:128 nt
    s_cbranch_vccnz L_sk_4
    s_waitcnt vmcnt(2)
L_sk_4:
    s_waitcnt vmcnt(7)
    buffer_load_dwordx4 v[96:99], v2, s[44:47], s8 offen offset:256 nt
    s_cbranch_vccnz L_fc_5
    ds_read_b32 v12, v10 offset:8
    s_waitcnt lgkmcnt(0)
    v_cmp_ne_u32 vcc, 0, v12
L_fc_5:
    s_add_u32 s8, s13, 3
    s_and_b32 s8, s8, 7
    s_mul_i32 s8, s8, 24576
    s_add_u32 s8, s8, s7
    s_cbranch_vccnz L_sk_6
    s_waitcnt vmcnt(2)
L_sk_6:
    s_waitcnt vmcnt(7)
    buffer_load_dwordx4 v[100:103], v2, s[44:47], s8 offen offset:0 nt
    s_cbranch_vccnz L_sk_7
    s_waitcnt vmcnt(2)
L_sk_7:
    s_waitcnt vmcnt(7)
    buffer_load_dwordx4 v[104:107], v2, s[44:47], s8 offen offset:128 nt
    s_cbranch_vccnz L_sk_8
    s_waitcnt vmcnt(2)
L_sk_8:
    s_waitcnt vmcnt(7)
    buffer_load_dwordx4 v[108:111], v2, s[44:47], s8 offen offset:256 nt
    s_cbranch_vccnz L_sk_9
    s_waitcnt vmcnt(2)
L_sk_9:
    s_waitcnt vmcnt(7)
    s_mov_b32 m0, s20
    s_nop 0
    buffer_load_dwordx4 v2, s[44:47], s16 offen nt lds
    s_cbranch_vccnz L_sk_10
    s_waitcnt vmcnt(2)
L_sk_10:
    s_waitcnt vmcnt(7)
    s_mov_b32 m0, s21
    s_nop 0
    buffer_load_dwordx4 v2, s[44:47], s17 offen nt lds
    s_cbranch_vccnz L_sk_11
    s_waitcnt vmcnt(2)
L_sk_11:
    s_waitcnt vmcnt(7)
    s_mov_b32 m0, s22
    s_nop 0
    buffer_load_dwordx4 v2, s[44:47], s18 offen nt lds
    s_cbranch_vccnz L_sk_12
    s_waitcnt vmcnt(2)
L_sk_12:
    s_waitcnt vmcnt(7)
    s_mov_b32 m0, s23
    s_nop 0
    buffer_load_dwordx4 v2, s[44:47], s19 offen nt lds
    s_cbranch_vccnz L_fc_13
    ds_read_b32 v12, v10 offset:8
    s_waitcnt lgkmcnt(0)
    v_cmp_ne_u32 vcc, 0, v12
L_fc_13:
    s_add_u32 s8, s13, 4
    s_and_b32 s8, s8, 7
    s_mul_i32 s8, s8, 24576
    s_add_u32 s8, s8, s7
    s_cbranch_vccnz L_sk_14
    s_waitcnt vmcnt(2)
L_sk_14:
    s_waitcnt vmcnt(7)
    buffer_load_dwordx4 v[112:115], v2, s[44:47], s8 offen offset:0 nt
    s_cbranch_vccnz L_sk_15
    s_waitcnt vmcnt(2)
L_sk_15:
    s_waitcnt vmcnt(7)
    buffer_load_dwordx4 v[116:119], v2, s[44:47], s8 offen offset:128 nt
    s_cbranch_vccnz L_sk_16
    s_waitcnt vmcnt(2)
L_sk_16:
    s_waitcnt vmcnt(7)
    buffer_load_dwordx4 v[120:123], v2, s[44:47], s8 offen offset:256 nt
    s_cbranch_vccnz L_fc_17
    ds_read_b32 v12, v10 offset:8
    s_waitcnt lgkmcnt(0)
    v_cmp_ne_u32 vcc, 0, v12
L_fc_17:
    s_add_u32 s8, s13, 5
    s_and_b32 s8, s8, 7
    s_mul_i32 s8, s8, 24576
    s_add_u32 s8, s8, s7
    s_cbranch_vccnz L_sk_18
    s_waitcnt vmcnt(2)
L_sk_18:
    s_waitcnt vmcnt(7)
    buffer_load_dwordx4 v[124:127], v2, s[44:47], s8 offen offset:0 nt
    s_cbranch_vccnz L_sk_19
    s_waitcnt vmcnt(2)
L_sk_19:
    s_waitcnt vmcnt(7)
    buffer_load_dwordx4 v[128:131], v2, s[44:47], s8 offen offset:128 nt
    s_cbranch_vccnz L_sk_20
    s_waitcnt vmcnt(2)
L_sk_20:
    s_waitcnt vmcnt(7)
    buffer_load_dwordx4 v[132:135], v2, s[44:47], s8 offen offset:256 nt
    s_cbranch_vccnz L_fc_21
    ds_read_b32 v12, v10 offset:8
    s_waitcnt lgkmcnt(0)
    v_cmp_ne_u32 vcc, 0, v12
L_fc_21:
    s_add_u32 s8, s13, 6
    s_and_b32 s8, s8, 7
    s_mul_i32 s8, s8, 24576
    s_add_u32 s8, s8, s7
    s_cbranch_vccnz L_sk_22
    s_waitcnt vmcnt(2)
L_sk_22:
    s_waitcnt vmcnt(7)
    buffer_load_dwordx4 v[136:139], v2, s[44:47], s8 offen offset:0 nt
    s_cbranch_vccnz L_sk_23
    s_waitcnt vmcnt(2)
L_sk_23:
    s_waitcnt vmcnt(7)
    s_mov_b32 exec_lo, 0x1
    s_mov_b32 exec_hi, 0x0
    ds_add_u32 v10, v11 offset:16
    s_mov_b64 exec, -1
    buffer_load_dwordx4 v[140:143], v2, s[44:47], s8 offen offset:128 nt
    s_cbranch_vccnz L_sk_24
    s_waitcnt vmcnt(2)
L_sk_24:
    s_waitcnt vmcnt(7)
    buffer_load_dwordx4 v[144:147], v2, s[44:47], s8 offen offset:256 nt
    s_cbranch_vccnz L_fc_25
    ds_read_b32 v12, v10 offset:8
    s_waitcnt lgkmcnt(0)
    v_cmp_ne_u32 vcc, 0, v12
L_fc_25:
    s_add_u32 s8, s13, 7
    s_and_b32 s8, s8, 7
    s_mul_i32 s8, s8, 24576
    s_add_u32 s8, s8, s7
    s_cbranch_vccnz L_sk_26
    s_waitcnt vmcnt(2)
L_sk_26:
    s_waitcnt vmcnt(7)
    buffer_load_dwordx4 v[148:151], v2, s[44:47], s8 offen offset:0 nt
    s_cbranch_vccnz L_sk_27
    s_waitcnt vmcnt(2)
L_sk_27:
    s_waitcnt vmcnt(7)
    buffer_load_dwordx4 v[152:155], v2, s[44:47], s8 offen offset:128 nt
    s_cbranch_vccnz L_sk_28
    s_waitcnt vmcnt(2)
L_sk_28:
    s_waitcnt vmcnt(7)
    buffer_load_dwordx4 v[156:159], v2, s[44:47], s8 offen offset:256 nt
    s_cbranch_vccnz L_fc_29
    ds_read_b32 v12, v10 offset:8
    s_waitcnt lgkmcnt(0)
    v_cmp_ne_u32 vcc, 0, v12
L_fc_29:
    s_add_u32 s8, s13, 0
    s_and_b32 s8, s8, 7
    s_mul_i32 s8, s8, 24576
    s_add_u32 s8, s8, s7
    s_cbranch_vccnz L_sk_30
    s_waitcnt vmcnt(2)
L_sk_30:
    s_waitcnt vmcnt(7)
    buffer_load_dwordx4 v[160:163], v3, s[48:51], s8 offen offset:0 nt
    s_cbranch_vccnz L_sk_31
    s_waitcnt vmcnt(2)
L_sk_31:
    s_waitcnt vmcnt(7)
    buffer_load_dwordx4 v[164:167], v3, s[48:51], s8 offen offset:128 nt
    s_cbranch_vccnz L_sk_32
    s_waitcnt vmcnt(2)
L_sk_32:
    s_waitcnt vmcnt(7)
    buffer_load_dwordx4 v[168:171], v3, s[48:51], s8 offen offset:256 nt
    s_cbranch_vccnz L_sk_33
    s_waitcnt vmcnt(2)
L_sk_33:
    s_waitcnt vmcnt(7)
    s_mov_b32 m0, s64
    s_nop 0
    buffer_load_dwordx4 v3, s[48:51], s16 offen nt lds
    s_cbranch_vccnz L_sk_34
    s_waitcnt vmcnt(2)
L_sk_34:
    s_waitcnt vmcnt(7)
    s_mov_b32 m0, s65
    s_nop 0
    buffer_load_dwordx4 v3, s[48:51], s17 offen nt lds
    s_cbranch_vccnz L_sk_35
    s_waitcnt vmcnt(2)
L_sk_35:
    s_waitcnt vmcnt(7)
    s_mov_b32 m0, s66
    s_nop 0
    buffer_load_dwordx4 v3, s[48:51], s18 offen nt lds
    s_cbranch_vccnz L_sk_36
    s_waitcnt vmcnt(2)
L_sk_36:
    s_waitcnt vmcnt(7)
    s_mov_b32 m0, s67
    s_nop 0
    buffer_load_dwordx4 v3, s[48:51], s19 offen nt lds
    s_cbranch_vccnz L_fc_37
    ds_read_b32 v12, v10 offset:8
    s_waitcnt lgkmcnt(0)
    v_cmp_ne_u32 vcc, 0, v12
L_fc_37:
    s_add_u32 s8, s13, 1
    s_and_b32 s8, s8, 7
    s_mul_i32 s8, s8, 24576
    s_add_u32 s8, s8, s7
    s_cbranch_vccnz L_sk_38
    s_waitcnt vmcnt(2)
L_sk_38:
    s_waitcnt vmcnt(7)
    buffer_load_dwordx4 v[172:175], v3, s[48:51], s8 offen offset:0 nt
    s_cbranch_vccnz L_sk_39
    s_waitcnt vmcnt(2)
L_sk_39:
    s_waitcnt vmcnt(7)
    buffer_load_dwordx4 v[176:179], v3, s[48:51], s8 offen offset:128 nt
    s_cbranch_vccnz L_sk_40
    s_waitcnt vmcnt(2)
L_sk_40:
    s_waitcnt vmcnt(7)
    buffer_load_dwordx4 v[180:183], v3, s[48:51], s8 offen offset:256 nt
    s_cbranch_vccnz L_fc_41
    ds_read_b32 v12, v10 offset:8
    s_waitcnt lgkmcnt(0)
    v_cmp_ne_u32 vcc, 0, v12
L_fc_41:
    s_add_u32 s8, s13, 2
    s_and_b32 s8, s8, 7
    s_mul_i32 s8, s8, 24576
    s_add_u32 s8, s8, s7
    s_cbranch_vccnz L_sk_42
    s_waitcnt vmcnt(2)
L_sk_42:
    s_waitcnt vmcnt(7)
    buffer_load_dwordx4 v[184:187], v3, s[48:51], s8 offen offset:0 nt
    s_cbranch_vccnz L_sk_43
    s_waitcnt vmcnt(2)
L_sk_43:
    s_waitcnt vmcnt(7)
    buffer_load_dwordx4 v[188:191], v3, s[48:51], s8 offen offset:128 nt
    s_cbranch_vccnz L_sk_44
    s_waitcnt vmcnt(2)
L_sk_44:
    s_waitcnt vmcnt(7)
    buffer_load_dwordx4 v[192:195], v3, s[48:51], s8 offen offset:256 nt
    s_cbranch_vccnz L_fc_45
    ds_read_b32 v12, v10 offset:8
    s_waitcnt lgkmcnt(0)
    v_cmp_ne_u32 vcc, 0, v12
L_fc_45:
    s_add_u32 s8, s13, 3
    s_and_b32 s8, s8, 7
    s_mul_i32 s8, s8, 24576
    s_add_u32 s8, s8, s7
    s_cbranch_vccnz L_sk_46
    s_waitcnt vmcnt(2)
L_sk_46:
    s_waitcnt vmcnt(7)
    buffer_load_dwordx4 v[196:199], v3, s[48:51], s8 offen offset:0 nt
    s_cbranch_vccnz L_sk_47
    s_waitcnt vmcnt(2)
L_sk_47:
    s_waitcnt vmcnt(7)
    s_mov_b32 exec_lo, 0x1
    s_mov_b32 exec_hi, 0x0
    ds_add_u32 v10, v11 offset:20
    s_mov_b64 exec, -1
    buffer_load_dwordx4 v[200:203], v3, s[48:51], s8 offen offset:128 nt
    s_cbranch_vccnz L_sk_48
    s_waitcnt vmcnt(2)
L_sk_48:
    s_waitcnt vmcnt(7)
    buffer_load_dwordx4 v[204:207], v3, s[48:51], s8 offen offset:256 nt
    s_add_u32 s8, s13, 4
    s_and_b32 s8, s8, 7
    s_mul_i32 s8, s8, 24576
    s_add_u32 s8, s8, s7
    s_waitcnt vmcnt(7)
    buffer_load_dwordx4 v[208:211], v3, s[48:51], s8 offen offset:0 nt
    s_waitcnt vmcnt(7)
    buffer_load_dwordx4 v[212:215], v3, s[48:51], s8 offen offset:128 nt
    s_waitcnt vmcnt(7)
    buffer_load_dwordx4 v[216:219], v3, s[48:51], s8 offen offset:256 nt
    ds_read_b32 v11, v10 offset:8
    s_waitcnt lgkmcnt(0)
    v_cmp_eq_u32 vcc, 0, v11
    s_cbranch_vccnz L_late
    v_and_b32 v6, 1, v4
    v_lshl_add_u32 v6, v6, 2, v5
    v_lshlrev_b32 v6, 4, v6
    v_add_u32 v6, 155648, v6
    ds_read_b128 v[8:11], v6
    ds_read_b128 v[12:15], v6 offset:128
    ds_read_b128 v[16:19], v6 offset:256
    v_and_b32 v6, 1, v4
    v_mov_b32 v7, 0xffff
    v_lshlrev_b32 v6, 4, v6
    v_lshlrev_b32 v7, v6, v7
    v_bfe_u32 v6, v4, 1, 2
    v_cmp_eq_u32 vcc, 0, v6
    s_nop 1
    v_cndmask_b32 v52, 0, v7, vcc
    v_cmp_eq_u32 vcc, 1, v6
    s_nop 1
    v_cndmask_b32 v53, 0, v7, vcc
    v_cmp_eq_u32 vcc, 2, v6
    s_nop 1
    v_cndmask_b32 v54, 0, v7, vcc
    v_cmp_eq_u32 vcc, 3, v6
    s_nop 1
    v_cndmask_b32 v55, 0, v7, vcc
    s_waitcnt lgkmcnt(0)
    s_waitcnt vmcnt(44)
    v_mfma_f32_16x16x32_bf16 v[20:23], v[64:67], v[8:11], 0
    v_mfma_f32_16x16x32_bf16 v[20:23], v[68:71], v[12:15], v[20:23]
    v_mfma_f32_16x16x32_bf16 v[20:23], v[72:75], v[16:19], v[20:23]
    s_waitcnt vmcnt(41)
    v_mfma_f32_16x16x32_bf16 v[24:27], v[76:79], v[8:11], 0
    v_mfma_f32_16x16x32_bf16 v[24:27], v[80:83], v[12:15], v[24:27]
    v_mfma_f32_16x16x32_bf16 v[24:27], v[84:87], v[16:19], v[24:27]
    s_waitcnt vmcnt(38)
    v_mfma_f32_16x16x32_bf16 v[28:31], v[88:91], v[8:11], 0
    v_mfma_f32_16x16x32_bf16 v[28:31], v[92:95], v[12:15], v[28:31]
    v_mfma_f32_16x16x32_bf16 v[28:31], v[96:99], v[16:19], v[28:31]
    s_waitcnt vmcnt(35)
    v_mfma_f32_16x16x32_bf16 v[32:35], v[100:103], v[8:11], 0
    v_mfma_f32_16x16x32_bf16 v[32:35], v[104:107], v[12:15], v[32:35]
    v_mfma_f32_16x16x32_bf16 v[32:35], v[108:111], v[16:19], v[32:35]
    s_waitcnt vmcnt(28)
    v_mfma_f32_16x16x32_bf16 v[36:39], v[112:115], v[8:11], 0
    v_mfma_f32_16x16x32_bf16 v[36:39], v[116:119], v[12:15], v[36:39]
    v_mfma_f32_16x16x32_bf16 v[36:39], v[120:123], v[16:19], v[36:39]
    s_waitcnt vmcnt(25)
    v_mfma_f32_16x16x32_bf16 v[40:43], v[124:127], v[8:11], 0
    v_mfma_f32_16x16x32_bf16 v[40:43], v[128:131], v[12:15], v[40:43]
    v_mfma_f32_16x16x32_bf16 v[40:43], v[132:135], v[16:19], v[40:43]
    s_waitcnt vmcnt(22)
    v_mfma_f32_16x16x32_bf16 v[44:47], v[136:139], v[8:11], 0
    v_mfma_f32_16x16x32_bf16 v[44:47], v[140:143], v[12:15], v[44:47]
    v_mfma_f32_16x16x32_bf16 v[44:47], v[144:147], v[16:19], v[44:47]
    s_waitcnt vmcnt(19)
    v_mfma_f32_16x16x32_bf16 v[48:51], v[148:151], v[8:11], 0
    v_mfma_f32_16x16x32_bf16 v[48:51], v[152:155], v[12:15], v[48:51]
    v_mfma_f32_16x16x32_bf16 v[48:51], v[156:159], v[16:19], v[48:51]
    s_add_u32 s8, s13, 5
    s_and_b32 s8, s8, 7
    s_mul_i32 s8, s8, 24576
    s_add_u32 s8, s8, s7
    s_setprio 2
    s_waitcnt vmcnt(7)
    buffer_load_dwordx4 v[220:223], v3, s[48:51], s8 offen offset:0 nt
    s_waitcnt vmcnt(7)
    buffer_load_dwordx4 v[224:227], v3, s[48:51], s8 offen offset:128 nt
    s_waitcnt vmcnt(7)
    buffer_load_dwordx4 v[228:231], v3, s[48:51], s8 offen offset:256 nt
    v_cndmask_b32 v20, v20, v21, s[72:73]
    v_cndmask_b32 v22, v22, v23, s[72:73]
    v_cndmask_b32 v20, v20, v22, s[74:75]
    v_cndmask_b32 v24, v24, v25, s[72:73]
    v_cndmask_b32 v26, v26, v27, s[72:73]
    v_cndmask_b32 v24, v24, v26, s[74:75]
    v_cndmask_b32 v28, v28, v29, s[72:73]
    v_cndmask_b32 v30, v30, v31, s[72:73]
    v_cndmask_b32 v28, v28, v30, s[74:75]
    v_cndmask_b32 v32, v32, v33, s[72:73]
    v_cndmask_b32 v34, v34, v35, s[72:73]
    v_cndmask_b32 v32, v32, v34, s[74:75]
    v_cndmask_b32 v36, v36, v37, s[72:73]
    v_cndmask_b32 v38, v38, v39, s[72:73]
    v_cndmask_b32 v36, v36, v38, s[74:75]
    v_cndmask_b32 v40, v40, v41, s[72:73]
    v_cndmask_b32 v42, v42, v43, s[72:73]
    v_cndmask_b32 v40, v40, v42, s[74:75]
    v_cndmask_b32 v44, v44, v45, s[72:73]
    v_cndmask_b32 v46, v46, v47, s[72:73]
    v_cndmask_b32 v44, v44, v46, s[74:75]
    v_cndmask_b32 v48, v48, v49, s[72:73]
    v_cndmask_b32 v50, v50, v51, s[72:73]
    v_cndmask_b32 v48, v48, v50, s[74:75]
    v_add_f32_dpp v20, v20, v20 quad_perm:[1,0,3,2] row_mask:0xf bank_mask:0xf
    v_add_f32_dpp v24, v24, v24 quad_perm:[1,0,3,2] row_mask:0xf bank_mask:0xf
    v_add_f32_dpp v28, v28, v28 quad_perm:[1,0,3,2] row_mask:0xf bank_mask:0xf
    v_add_f32_dpp v32, v32, v32 quad_perm:[1,0,3,2] row_mask:0xf bank_mask:0xf
    v_add_f32_dpp v36, v36, v36 quad_perm:[1,0,3,2] row_mask:0xf bank_mask:0xf
    v_add_f32_dpp v40, v40, v40 quad_perm:[1,0,3,2] row_mask:0xf bank_mask:0xf
    v_add_f32_dpp v44, v44, v44 quad_perm:[1,0,3,2] row_mask:0xf bank_mask:0xf
    v_add_f32_dpp v48, v48, v48 quad_perm:[1,0,3,2] row_mask:0xf bank_mask:0xf
    v_cvt_pk_bf16_f32 v21, v20, v24
    v_lshlrev_b32 v20, 16, v21
    v_and_b32 v24, 0xffff0000, v21
    v_cvt_pk_bf16_f32 v29, v28, v32
    v_lshlrev_b32 v28, 16, v29
    v_and_b32 v32, 0xffff0000, v29
    v_cvt_pk_bf16_f32 v37, v36, v40
    v_lshlrev_b32 v36, 16, v37
    v_and_b32 v40, 0xffff0000, v37
    v_cvt_pk_bf16_f32 v45, v44, v48
    v_lshlrev_b32 v44, 16, v45
    v_and_b32 v48, 0xffff0000, v45
    v_mul_f32 v20, 0x3d93cd3a, v20
    v_mul_f32 v24, 0x3d93cd3a, v24
    v_mul_f32 v28, 0x3d93cd3a, v28
    v_mul_f32 v32, 0x3d93cd3a, v32
    v_mul_f32 v36, 0x3d93cd3a, v36
    v_mul_f32 v40, 0x3d93cd3a, v40
    v_mul_f32 v44, 0x3d93cd3a, v44
    v_mul_f32 v48, 0x3d93cd3a, v48
    v_cvt_pk_bf16_f32 v21, v20, v24
    v_lshlrev_b32 v20, 16, v21
    v_and_b32 v24, 0xffff0000, v21
    v_cvt_pk_bf16_f32 v29, v28, v32
    v_lshlrev_b32 v28, 16, v29
    v_and_b32 v32, 0xffff0000, v29
    v_cvt_pk_bf16_f32 v37, v36, v40
    v_lshlrev_b32 v36, 16, v37
    v_and_b32 v40, 0xffff0000, v37
    v_cvt_pk_bf16_f32 v45, v44, v48
    v_lshlrev_b32 v44, 16, v45
    v_and_b32 v48, 0xffff0000, v45
    v_max3_f32 v56, v20, v24, v28
    v_max3_f32 v56, v56, v32, v36
    v_max3_f32 v56, v56, v40, v44
    v_max_f32 v56, v56, v48
    s_nop 1
    v_max_f32_dpp v56, v56, v56 row_ror:8 row_mask:0xf bank_mask:0xf
    v_mov_b32 v58, v56
    s_nop 1
    v_permlane16_swap_b32 v56, v58
    v_max_f32 v56, v56, v58
    v_mov_b32 v58, v56
    s_nop 1
    v_permlane32_swap_b32 v56, v58
    v_max_f32 v56, v56, v58
    v_sub_f32 v20, v20, v56
    v_sub_f32 v24, v24, v56
    v_sub_f32 v28, v28, v56
    v_sub_f32 v32, v32, v56
    v_sub_f32 v36, v36, v56
    v_sub_f32 v40, v40, v56
    v_sub_f32 v44, v44, v56
    v_sub_f32 v48, v48, v56
    v_mul_f32 v20, 0x3fb8aa3b, v20
    v_mul_f32 v24, 0x3fb8aa3b, v24
    v_mul_f32 v28, 0x3fb8aa3b, v28
    v_mul_f32 v32, 0x3fb8aa3b, v32
    v_mul_f32 v36, 0x3fb8aa3b, v36
    v_mul_f32 v40, 0x3fb8aa3b, v40
    v_mul_f32 v44, 0x3fb8aa3b, v44
    v_mul_f32 v48, 0x3fb8aa3b, v48
    v_exp_f32 v20, v20
    v_exp_f32 v24, v24
    v_exp_f32 v28, v28
    v_exp_f32 v32, v32
    v_exp_f32 v36, v36
    v_exp_f32 v40, v40
    v_exp_f32 v44, v44
    v_exp_f32 v48, v48
    v_add_f32 v57, v20, v24
    v_add_f32 v57, v57, v28
    v_add_f32 v57, v57, v32
    v_add_f32 v57, v57, v36
    v_add_f32 v57, v57, v40
    v_add_f32 v57, v57, v44
    v_add_f32 v57, v57, v48
    v_cvt_pk_bf16_f32 v8, v20, v20
    v_cvt_pk_bf16_f32 v9, v24, v24
    v_cvt_pk_bf16_f32 v10, v28, v28
    v_cvt_pk_bf16_f32 v11, v32, v32
    v_cvt_pk_bf16_f32 v12, v36, v36
    v_cvt_pk_bf16_f32 v13, v40, v40
    v_cvt_pk_bf16_f32 v14, v44, v44
    v_cvt_pk_bf16_f32 v15, v48, v48
    v_add_f32_dpp v57, v57, v57 row_ror:8 row_mask:0xf bank_mask:0xf
    v_mov_b32 v58, v57
    s_nop 1
    v_permlane16_swap_b32 v57, v58
    v_add_f32 v57, v57, v58
    v_mov_b32 v58, v57
    s_nop 1
    v_permlane32_swap_b32 v57, v58
    v_add_f32 v57, v57, v58
    s_lshl_b32 s9, s3, 3
    s_add_u32 s9, s9, 156160
    v_mov_b32 v6, s9
    ds_write_b64 v6, v[56:57]
    s_add_u32 s8, s13, 6
    s_and_b32 s8, s8, 7
    s_mul_i32 s8, s8, 24576
    s_add_u32 s8, s8, s7
    s_setprio 1
    s_waitcnt vmcnt(7)
    buffer_load_dwordx4 v[232:235], v3, s[48:51], s8 offen offset:0 nt
    s_waitcnt vmcnt(7)
    buffer_load_dwordx4 v[236:239], v3, s[48:51], s8 offen offset:128 nt
    s_waitcnt vmcnt(7)
    buffer_load_dwordx4 v[240:243], v3, s[48:51], s8 offen offset:256 nt
    v_and_b32 v32, v8, v52
    v_and_b32 v33, v8, v53
    v_and_b32 v34, v8, v54
    v_and_b32 v35, v8, v55
    s_waitcnt vmcnt(22)
    s_nop 0
    v_mfma_f32_16x16x32_bf16 v[20:23], v[32:35], v[160:163], 0
    v_mfma_f32_16x16x32_bf16 v[24:27], v[32:35], v[164:167], 0
    v_mfma_f32_16x16x32_bf16 v[28:31], v[32:35], v[168:171], 0
    v_and_b32 v36, v9, v52
    v_and_b32 v37, v9, v53
    v_and_b32 v38, v9, v54
    v_and_b32 v39, v9, v55
    s_waitcnt vmcnt(15)
    s_nop 0
    v_mfma_f32_16x16x32_bf16 v[20:23], v[36:39], v[172:175], v[20:23]
    v_mfma_f32_16x16x32_bf16 v[24:27], v[36:39], v[176:179], v[24:27]
    v_mfma_f32_16x16x32_bf16 v[28:31], v[36:39], v[180:183], v[28:31]
    v_and_b32 v32, v10, v52
    v_and_b32 v33, v10, v53
    v_and_b32 v34, v10, v54
    v_and_b32 v35, v10, v55
    s_waitcnt vmcnt(12)
    s_nop 0
    v_mfma_f32_16x16x32_bf16 v[20:23], v[32:35], v[184:187], v[20:23]
    v_mfma_f32_16x16x32_bf16 v[24:27], v[32:35], v[188:191], v[24:27]
    v_mfma_f32_16x16x32_bf16 v[28:31], v[32:35], v[192:195], v[28:31]
    v_and_b32 v36, v11, v52
    v_and_b32 v37, v11, v53
    v_and_b32 v38, v11, v54
    v_and_b32 v39, v11, v55
    s_waitcnt vmcnt(9)
    s_nop 0
    v_mfma_f32_16x16x32_bf16 v[20:23], v[36:39], v[196:199], v[20:23]
    v_mfma_f32_16x16x32_bf16 v[24:27], v[36:39], v[200:203], v[24:27]
    v_mfma_f32_16x16x32_bf16 v[28:31], v[36:39], v[204:207], v[28:31]
    v_and_b32 v32, v12, v52
    v_and_b32 v33, v12, v53
    v_and_b32 v34, v12, v54
    v_and_b32 v35, v12, v55
    s_waitcnt vmcnt(6)
    s_nop 0
    v_mfma_f32_16x16x32_bf16 v[20:23], v[32:35], v[208:211], v[20:23]
    v_mfma_f32_16x16x32_bf16 v[24:27], v[32:35], v[212:215], v[24:27]
    v_mfma_f32_16x16x32_bf16 v[28:31], v[32:35], v[216:219], v[28:31]
    s_add_u32 s8, s13, 7
    s_and_b32 s8, s8, 7
    s_mul_i32 s8, s8, 24576
    s_add_u32 s8, s8, s7
    s_setprio 0
    s_waitcnt vmcnt(7)
    buffer_load_dwordx4 v[244:247], v3, s[48:51], s8 offen offset:0 nt
    s_waitcnt vmcnt(7)
    buffer_load_dwordx4 v[248:251], v3, s[48:51], s8 offen offset:128 nt
    s_waitcnt vmcnt(7)
    buffer_load_dwordx4 v[252:255], v3, s[48:51], s8 offen offset:256 nt
    v_and_b32 v36, v13, v52
    v_and_b32 v37, v13, v53
    v_and_b32 v38, v13, v54
    v_and_b32 v39, v13, v55
    s_waitcnt vmcnt(6)
    s_nop 0
    v_mfma_f32_16x16x32_bf16 v[20:23], v[36:39], v[220:223], v[20:23]
    v_mfma_f32_16x16x32_bf16 v[24:27], v[36:39], v[224:227], v[24:27]
    v_mfma_f32_16x16x32_bf16 v[28:31], v[36:39], v[228:231], v[28:31]
    v_and_b32 v32, v14, v52
    v_and_b32 v33, v14, v53
    v_and_b32 v34, v14, v54
    v_and_b32 v35, v14, v55
    s_waitcnt vmcnt(3)
    s_nop 0
    v_mfma_f32_16x16x32_bf16 v[20:23], v[32:35], v[232:235], v[20:23]
    v_mfma_f32_16x16x32_bf16 v[24:27], v[32:35], v[236:239], v[24:27]
    v_mfma_f32_16x16x32_bf16 v[28:31], v[32:35], v[240:243], v[28:31]
    v_and_b32 v36, v15, v52
    v_and_b32 v37, v15, v53
    v_and_b32 v38, v15, v54
    v_and_b32 v39, v15, v55
    s_cmp_eq_u32 s3, 7
    s_cbranch_scc0 L_tk_49
    s_mov_b32 s36, 1
    s_atomic_add s36, s[40:41], 0 glc
L_tk_49:
    s_waitcnt vmcnt(0)
    v_mfma_f32_16x16x32_bf16 v[20:23], v[36:39], v[244:247], v[20:23]
    v_mfma_f32_16x16x32_bf16 v[24:27], v[36:39], v[248:251], v[24:27]
    v_mfma_f32_16x16x32_bf16 v[28:31], v[36:39], v[252:255], v[28:31]
    s_branch L_tail
L_late:
    s_add_u32 s8, s13, 5
    s_and_b32 s8, s8, 7
    s_mul_i32 s8, s8, 24576
    s_add_u32 s8, s8, s7
    s_setprio 2
    s_waitcnt vmcnt(7)
    buffer_load_dwordx4 v[220:223], v3, s[48:51], s8 offen offset:0 nt
    s_waitcnt vmcnt(7)
    buffer_load_dwordx4 v[224:227], v3, s[48:51], s8 offen offset:128 nt
    s_waitcnt vmcnt(7)
    buffer_load_dwordx4 v[228:231], v3, s[48:51], s8 offen offset:256 nt
    s_add_u32 s8, s13, 6
    s_and_b32 s8, s8, 7
    s_mul_i32 s8, s8, 24576
    s_add_u32 s8, s8, s7
    s_setprio 1
    s_waitcnt vmcnt(7)
    buffer_load_dwordx4 v[232:235], v3, s[48:51], s8 offen offset:0 nt
    s_waitcnt vmcnt(7)
    buffer_load_dwordx4 v[236:239], v3, s[48:51], s8 offen offset:128 nt
    s_waitcnt vmcnt(7)
    buffer_load_dwordx4 v[240:243], v3, s[48:51], s8 offen offset:256 nt
    s_add_u32 s8, s13, 7
    s_and_b32 s8, s8, 7
    s_mul_i32 s8, s8, 24576
    s_add_u32 s8, s8, s7
    s_setprio 0
    s_waitcnt vmcnt(7)
    buffer_load_dwordx4 v[244:247], v3, s[48:51], s8 offen offset:0 nt
    s_waitcnt vmcnt(7)
    buffer_load_dwordx4 v[248:251], v3, s[48:51], s8 offen offset:128 nt
    s_waitcnt vmcnt(7)
    buffer_load_dwordx4 v[252:255], v3, s[48:51], s8 offen offset:256 nt
L_late_q:
    ds_read_b32 v11, v10 offset:8
    s_waitcnt lgkmcnt(0)
    v_cmp_gt_u32 vcc, 1, v11
    s_cbranch_vccz L_late_q_ok
    s_sleep 1
    s_sub_u32 s84, s84, 1
    s_cmp_lg_u32 s84, 0
    s_cbranch_scc1 L_late_q
L_late_q_ok:
L_attB:
    v_and_b32 v6, 1, v4
    v_lshl_add_u32 v6, v6, 2, v5
    v_lshlrev_b32 v6, 4, v6
    v_add_u32 v6, 155648, v6
    ds_read_b128 v[8:11], v6
    ds_read_b128 v[12:15], v6 offset:128
    ds_read_b128 v[16:19], v6 offset:256
    v_and_b32 v6, 1, v4
    v_mov_b32 v7, 0xffff
    v_lshlrev_b32 v6, 4, v6
    v_lshlrev_b32 v7, v6, v7
    v_bfe_u32 v6, v4, 1, 2
    v_cmp_eq_u32 vcc, 0, v6
    s_nop 1
    v_cndmask_b32 v52, 0, v7, vcc
    v_cmp_eq_u32 vcc, 1, v6
    s_nop 1
    v_cndmask_b32 v53, 0, v7, vcc
    v_cmp_eq_u32 vcc, 2, v6
    s_nop 1
    v_cndmask_b32 v54, 0, v7, vcc
    v_cmp_eq_u32 vcc, 3, v6
    s_nop 1
    v_cndmask_b32 v55, 0, v7, vcc
    s_waitcnt lgkmcnt(0)
    s_waitcnt vmcnt(53)
    v_mfma_f32_16x16x32_bf16 v[20:23], v[64:67], v[8:11], 0
    v_mfma_f32_16x16x32_bf16 v[20:23], v[68:71], v[12:15], v[20:23]
    v_mfma_f32_16x16x32_bf16 v[20:23], v[72:75], v[16:19], v[20:23]
    s_waitcnt vmcnt(50)
    v_mfma_f32_16x16x32_bf16 v[24:27], v[76:79], v[8:11], 0
    v_mfma_f32_16x16x32_bf16 v[24:27], v[80:83], v[12:15], v[24:27]
    v_mfma_f32_16x16x32_bf16 v[24:27], v[84:87], v[16:19], v[24:27]
    s_waitcnt vmcnt(47)
    v_mfma_f32_16x16x32_bf16 v[28:31], v[88:91], v[8:11], 0
    v_mfma_f32_16x16x32_bf16 v[28:31], v[92:95], v[12:15], v[28:31]
    v_mfma_f32_16x16x32_bf16 v[28:31], v[96:99], v[16:19], v[28:31]
    s_waitcnt vmcnt(44)
    v_mfma_f32_16x16x32_bf16 v[32:35], v[100:103], v[8:11], 0
    v_mfma_f32_16x16x32_bf16 v[32:35], v[104:107], v[12:15], v[32:35]
    v_mfma_f32_16x16x32_bf16 v[32:35], v[108:111], v[16:19], v[32:35]
    s_waitcnt vmcnt(37)
    v_mfma_f32_16x16x32_bf16 v[36:39], v[112:115], v[8:11], 0
    v_mfma_f32_16x16x32_bf16 v[36:39], v[116:119], v[12:15], v[36:39]
    v_mfma_f32_16x16x32_bf16 v[36:39], v[120:123], v[16:19], v[36:39]
    s_waitcnt vmcnt(34)
    v_mfma_f32_16x16x32_bf16 v[40:43], v[124:127], v[8:11], 0
    v_mfma_f32_16x16x32_bf16 v[40:43], v[128:131], v[12:15], v[40:43]
    v_mfma_f32_16x16x32_bf16 v[40:43], v[132:135], v[16:19], v[40:43]
    s_waitcnt vmcnt(31)
    v_mfma_f32_16x16x32_bf16 v[44:47], v[136:139], v[8:11], 0
    v_mfma_f32_16x16x32_bf16 v[44:47], v[140:143], v[12:15], v[44:47]
    v_mfma_f32_16x16x32_bf16 v[44:47], v[144:147], v[16:19], v[44:47]
    s_waitcnt vmcnt(28)
    v_mfma_f32_16x16x32_bf16 v[48:51], v[148:151], v[8:11], 0
    v_mfma_f32_16x16x32_bf16 v[48:51], v[152:155], v[12:15], v[48:51]
    v_mfma_f32_16x16x32_bf16 v[48:51], v[156:159], v[16:19], v[48:51]
    v_cndmask_b32 v20, v20, v21, s[72:73]
    v_cndmask_b32 v22, v22, v23, s[72:73]
    v_cndmask_b32 v20, v20, v22, s[74:75]
    v_cndmask_b32 v24, v24, v25, s[72:73]
    v_cndmask_b32 v26, v26, v27, s[72:73]
    v_cndmask_b32 v24, v24, v26, s[74:75]
    v_cndmask_b32 v28, v28, v29, s[72:73]
    v_cndmask_b32 v30, v30, v31, s[72:73]
    v_cndmask_b32 v28, v28, v30, s[74:75]
    v_cndmask_b32 v32, v32, v33, s[72:73]
    v_cndmask_b32 v34, v34, v35, s[72:73]
    v_cndmask_b32 v32, v32, v34, s[74:75]
    v_cndmask_b32 v36, v36, v37, s[72:73]
    v_cndmask_b32 v38, v38, v39, s[72:73]
    v_cndmask_b32 v36, v36, v38, s[74:75]
    v_cndmask_b32 v40, v40, v41, s[72:73]
    v_cndmask_b32 v42, v42, v43, s[72:73]
    v_cndmask_b32 v40, v40, v42, s[74:75]
    v_cndmask_b32 v44, v44, v45, s[72:73]
    v_cndmask_b32 v46, v46, v47, s[72:73]
    v_cndmask_b32 v44, v44, v46, s[74:75]
    v_cndmask_b32 v48, v48, v49, s[72:73]
    v_cndmask_b32 v50, v50, v51, s[72:73]
    v_cndmask_b32 v48, v48, v50, s[74:75]
    v_add_f32_dpp v20, v20, v20 quad_perm:[1,0,3,2] row_mask:0xf bank_mask:0xf
    v_add_f32_dpp v24, v24, v24 quad_perm:[1,0,3,2] row_mask:0xf bank_mask:0xf
    v_add_f32_dpp v28, v28, v28 quad_perm:[1,0,3,2] row_mask:0xf bank_mask:0xf
    v_add_f32_dpp v32, v32, v32 quad_perm:[1,0,3,2] row_mask:0xf bank_mask:0xf
    v_add_f32_dpp v36, v36, v36 quad_perm:[1,0,3,2] row_mask:0xf bank_mask:0xf
    v_add_f32_dpp v40, v40, v40 quad_perm:[1,0,3,2] row_mask:0xf bank_mask:0xf
    v_add_f32_dpp v44, v44, v44 quad_perm:[1,0,3,2] row_mask:0xf bank_mask:0xf
    v_add_f32_dpp v48, v48, v48 quad_perm:[1,0,3,2] row_mask:0xf bank_mask:0xf
    v_cvt_pk_bf16_f32 v21, v20, v24
    v_lshlrev_b32 v20, 16, v21
    v_and_b32 v24, 0xffff0000, v21
    v_cvt_pk_bf16_f32 v29, v28, v32
    v_lshlrev_b32 v28, 16, v29
    v_and_b32 v32, 0xffff0000, v29
    v_cvt_pk_bf16_f32 v37, v36, v40
    v_lshlrev_b32 v36, 16, v37
    v_and_b32 v40, 0xffff0000, v37
    v_cvt_pk_bf16_f32 v45, v44, v48
    v_lshlrev_b32 v44, 16, v45
    v_and_b32 v48, 0xffff0000, v45
    v_mul_f32 v20, 0x3d93cd3a, v20
    v_mul_f32 v24, 0x3d93cd3a, v24
    v_mul_f32 v28, 0x3d93cd3a, v28
    v_mul_f32 v32, 0x3d93cd3a, v32
    v_mul_f32 v36, 0x3d93cd3a, v36
    v_mul_f32 v40, 0x3d93cd3a, v40
    v_mul_f32 v44, 0x3d93cd3a, v44
    v_mul_f32 v48, 0x3d93cd3a, v48
    v_cvt_pk_bf16_f32 v21, v20, v24
    v_lshlrev_b32 v20, 16, v21
    v_and_b32 v24, 0xffff0000, v21
    v_cvt_pk_bf16_f32 v29, v28, v32
    v_lshlrev_b32 v28, 16, v29
    v_and_b32 v32, 0xffff0000, v29
    v_cvt_pk_bf16_f32 v37, v36, v40
    v_lshlrev_b32 v36, 16, v37
    v_and_b32 v40, 0xffff0000, v37
    v_cvt_pk_bf16_f32 v45, v44, v48
    v_lshlrev_b32 v44, 16, v45
    v_and_b32 v48, 0xffff0000, v45
    v_max3_f32 v56, v20, v24, v28
    v_max3_f32 v56, v56, v32, v36
    v_max3_f32 v56, v56, v40, v44
    v_max_f32 v56, v56, v48
    s_nop 1
    v_max_f32_dpp v56, v56, v56 row_ror:8 row_mask:0xf bank_mask:0xf
    v_mov_b32 v58, v56
    s_nop 1
    v_permlane16_swap_b32 v56, v58
    v_max_f32 v56, v56, v58
    v_mov_b32 v58, v56
    s_nop 1
    v_permlane32_swap_b32 v56, v58
    v_max_f32 v56, v56, v58
    v_sub_f32 v20, v20, v56
    v_sub_f32 v24, v24, v56
    v_sub_f32 v28, v28, v56
    v_sub_f32 v32, v32, v56
    v_sub_f32 v36, v36, v56
    v_sub_f32 v40, v40, v56
    v_sub_f32 v44, v44, v56
    v_sub_f32 v48, v48, v56
    v_mul_f32 v20, 0x3fb8aa3b, v20
    v_mul_f32 v24, 0x3fb8aa3b, v24
    v_mul_f32 v28, 0x3fb8aa3b, v28
    v_mul_f32 v32, 0x3fb8aa3b, v32
    v_mul_f32 v36, 0x3fb8aa3b, v36
    v_mul_f32 v40, 0x3fb8aa3b, v40
    v_mul_f32 v44, 0x3fb8aa3b, v44
    v_mul_f32 v48, 0x3fb8aa3b, v48
    v_exp_f32 v20, v20
    v_exp_f32 v24, v24
    v_exp_f32 v28, v28
    v_exp_f32 v32, v32
    v_exp_f32 v36, v36
    v_exp_f32 v40, v40
    v_exp_f32 v44, v44
    v_exp_f32 v48, v48
    v_add_f32 v57, v20, v24
    v_add_f32 v57, v57, v28
    v_add_f32 v57, v57, v32
    v_add_f32 v57, v57, v36
    v_add_f32 v57, v57, v40
    v_add_f32 v57, v57, v44
    v_add_f32 v57, v57, v48
    v_cvt_pk_bf16_f32 v8, v20, v20
    v_cvt_pk_bf16_f32 v9, v24, v24
    v_cvt_pk_bf16_f32 v10, v28, v28
    v_cvt_pk_bf16_f32 v11, v32, v32
    v_cvt_pk_bf16_f32 v12, v36, v36
    v_cvt_pk_bf16_f32 v13, v40, v40
    v_cvt_pk_bf16_f32 v14, v44, v44
    v_cvt_pk_bf16_f32 v15, v48, v48
    v_add_f32_dpp v57, v57, v57 row_ror:8 row_mask:0xf bank_mask:0xf
    v_mov_b32 v58, v57
    s_nop 1
    v_permlane16_swap_b32 v57, v58
    v_add_f32 v57, v57, v58
    v_mov_b32 v58, v57
    s_nop 1
    v_permlane32_swap_b32 v57, v58
    v_add_f32 v57, v57, v58
    s_lshl_b32 s9, s3, 3
    s_add_u32 s9, s9, 156160
    v_mov_b32 v6, s9
    ds_write_b64 v6, v[56:57]
    v_and_b32 v32, v8, v52
    v_and_b32 v33, v8, v53
    v_and_b32 v34, v8, v54
    v_and_b32 v35, v8, v55
    s_waitcnt vmcnt(25)
    s_nop 0
    v_mfma_f32_16x16x32_bf16 v[20:23], v[32:35], v[160:163], 0
    v_mfma_f32_16x16x32_bf16 v[24:27], v[32:35], v[164:167], 0
    v_mfma_f32_16x16x32_bf16 v[28:31], v[32:35], v[168:171], 0
    v_and_b32 v36, v9, v52
    v_and_b32 v37, v9, v53
    v_and_b32 v38, v9, v54
    v_and_b32 v39, v9, v55
    s_waitcnt vmcnt(18)
    s_nop 0
    v_mfma_f32_16x16x32_bf16 v[20:23], v[36:39], v[172:175], v[20:23]
    v_mfma_f32_16x16x32_bf16 v[24:27], v[36:39], v[176:179], v[24:27]
    v_mfma_f32_16x16x32_bf16 v[28:31], v[36:39], v[180:183], v[28:31]
    v_and_b32 v32, v10, v52
    v_and_b32 v33, v10, v53
    v_and_b32 v34, v10, v54
    v_and_b32 v35, v10, v55
    s_waitcnt vmcnt(15)
    s_nop 0
    v_mfma_f32_16x16x32_bf16 v[20:23], v[32:35], v[184:187], v[20:23]
    v_mfma_f32_16x16x32_bf16 v[24:27], v[32:35], v[188:191], v[24:27]
    v_mfma_f32_16x16x32_bf16 v[28:31], v[32:35], v[192:195], v[28:31]
    v_and_b32 v36, v11, v52
    v_and_b32 v37, v11, v53
    v_and_b32 v38, v11, v54
    v_and_b32 v39, v11, v55
    s_waitcnt vmcnt(12)
    s_nop 0
    v_mfma_f32_16x16x32_bf16 v[20:23], v[36:39], v[196:199], v[20:23]
    v_mfma_f32_16x16x32_bf16 v[24:27], v[36:39], v[200:203], v[24:27]
    v_mfma_f32_16x16x32_bf16 v[28:31], v[36:39], v[204:207], v[28:31]
    v_and_b32 v32, v12, v52
    v_and_b32 v33, v12, v53
    v_and_b32 v34, v12, v54
    v_and_b32 v35, v12, v55
    s_waitcnt vmcnt(9)
    s_nop 0
    v_mfma_f32_16x16x32_bf16 v[20:23], v[32:35], v[208:211], v[20:23]
    v_mfma_f32_16x16x32_bf16 v[24:27], v[32:35], v[212:215], v[24:27]
    v_mfma_f32_16x16x32_bf16 v[28:31], v[32:35], v[216:219], v[28:31]
    v_and_b32 v36, v13, v52
    v_and_b32 v37, v13, v53
    v_and_b32 v38, v13, v54
    v_and_b32 v39, v13, v55
    s_waitcnt vmcnt(6)
    s_nop 0
    v_mfma_f32_16x16x32_bf16 v[20:23], v[36:39], v[220:223], v[20:23]
    v_mfma_f32_16x16x32_bf16 v[24:27], v[36:39], v[224:227], v[24:27]
    v_mfma_f32_16x16x32_bf16 v[28:31], v[36:39], v[228:231], v[28:31]
    v_and_b32 v32, v14, v52
    v_and_b32 v33, v14, v53
    v_and_b32 v34, v14, v54
    v_and_b32 v35, v14, v55
    s_waitcnt vmcnt(3)
    s_nop 0
    v_mfma_f32_16x16x32_bf16 v[20:23], v[32:35], v[232:235], v[20:23]
    v_mfma_f32_16x16x32_bf16 v[24:27], v[32:35], v[236:239], v[24:27]
    v_mfma_f32_16x16x32_bf16 v[28:31], v[32:35], v[240:243], v[28:31]
    v_and_b32 v36, v15, v52
    v_and_b32 v37, v15, v53
    v_and_b32 v38, v15, v54
    v_and_b32 v39, v15, v55
    s_cmp_eq_u32 s3, 7
    s_cbranch_scc0 L_tk_50
    s_mov_b32 s36, 1
    s_atomic_add s36, s[40:41], 0 glc
L_tk_50:
    s_waitcnt vmcnt(0)
    v_mfma_f32_16x16x32_bf16 v[20:23], v[36:39], v[244:247], v[20:23]
    v_mfma_f32_16x16x32_bf16 v[24:27], v[36:39], v[248:251], v[24:27]
    v_mfma_f32_16x16x32_bf16 v[28:31], v[36:39], v[252:255], v[28:31]
    s_branch L_tail
L_helper:
    s_setprio 3
    s_waitcnt lgkmcnt(0)
    s_add_u32 s85, s85, 1
    s_barrier
    s_cmp_ge_u32 s2, 240
    s_cbranch_scc1 L_h_nounit2
    s_waitcnt vmcnt(13)
    s_mov_b32 s9, 0xbfb8aa3b
    s_mov_b32 s10, 0x3f317218
    v_lshlrev_b32 v8, 16, v204
    v_and_b32 v9, 0xffff0000, v204
    v_mul_f32 v10, s9, v8
    v_mul_f32 v11, s9, v9
    v_fma_f32 v12, v8, s9, -v10
    v_fma_f32 v13, v9, s9, -v11
    v_exp_f32 v10, v10
    v_exp_f32 v11, v11
    v_fmac_f32 v12, 0xb2a57060, v8
    v_fmac_f32 v13, 0xb2a57060, v9
    v_mul_f32 v12, s10, v12
    v_mul_f32 v13, s10, v13
    v_min_f32 v10, 0x7f7fffff, v10
    v_min_f32 v11, 0x7f7fffff, v11
    v_fmac_f32 v10, v10, v12
    v_fmac_f32 v11, v11, v13
    v_add_f32 v10, 1.0, v10
    v_add_f32 v11, 1.0, v11
    v_min_f32 v10, 0x7f7fffff, v10
    v_min_f32 v11, 0x7f7fffff, v11
    v_rcp_f32 v12, v10
    v_rcp_f32 v13, v11
    v_mul_f32 v14, v8, v12
    v_mul_f32 v15, v9, v13
    v_fma_f32 v8, -v14, v10, v8
    v_fma_f32 v9, -v15, v11, v9
    v_fmac_f32 v14, v8, v12
    v_fmac_f32 v15, v9, v13
    v_cvt_pk_bf16_f32 v204, v14, v15
    v_lshlrev_b32 v8, 16, v205
    v_and_b32 v9, 0xffff0000, v205
    v_mul_f32 v10, s9, v8
    v_mul_f32 v11, s9, v9
    v_fma_f32 v12, v8, s9, -v10
    v_fma_f32 v13, v9, s9, -v11
    v_exp_f32 v10, v10
    v_exp_f32 v11, v11
    v_fmac_f32 v12, 0xb2a57060, v8
    v_fmac_f32 v13, 0xb2a57060, v9
    v_mul_f32 v12, s10, v12
    v_mul_f32 v13, s10, v13
    v_min_f32 v10, 0x7f7fffff, v10
    v_min_f32 v11, 0x7f7fffff, v11
    v_fmac_f32 v10, v10, v12
    v_fmac_f32 v11, v11, v13
    v_add_f32 v10, 1.0, v10
    v_add_f32 v11, 1.0, v11
    v_min_f32 v10, 0x7f7fffff, v10
    v_min_f32 v11, 0x7f7fffff, v11
    v_rcp_f32 v12, v10
    v_rcp_f32 v13, v11
    v_mul_f32 v14, v8, v12
    v_mul_f32 v15, v9, v13
    v_fma_f32 v8, -v14, v10, v8
    v_fma_f32 v9, -v15, v11, v9
    v_fmac_f32 v14, v8, v12
    v_fmac_f32 v15, v9, v13
    v_cvt_pk_bf16_f32 v205, v14, v15
    v_lshlrev_b32 v8, 16, v206
    v_and_b32 v9, 0xffff0000, v206
    v_mul_f32 v10, s9, v8
    v_mul_f32 v11, s9, v9
    v_fma_f32 v12, v8, s9, -v10
    v_fma_f32 v13, v9, s9, -v11
    v_exp_f32 v10, v10
    v_exp_f32 v11, v11
    v_fmac_f32 v12, 0xb2a57060, v8
    v_fmac_f32 v13, 0xb2a57060, v9
    v_mul_f32 v12, s10, v12
    v_mul_f32 v13, s10, v13
    v_min_f32 v10, 0x7f7fffff, v10
    v_min_f32 v11, 0x7f7fffff, v11
    v_fmac_f32 v10, v10, v12
    v_fmac_f32 v11, v11, v13
    v_add_f32 v10, 1.0, v10
    v_add_f32 v11, 1.0, v11
    v_min_f32 v10, 0x7f7fffff, v10
    v_min_f32 v11, 0x7f7fffff, v11
    v_rcp_f32 v12, v10
    v_rcp_f32 v13, v11
    v_mul_f32 v14, v8, v12
    v_mul_f32 v15, v9, v13
    v_fma_f32 v8, -v14, v10, v8
    v_fma_f32 v9, -v15, v11, v9
    v_fmac_f32 v14, v8, v12
    v_fmac_f32 v15, v9, v13
    v_cvt_pk_bf16_f32 v206, v14, v15
    v_lshlrev_b32 v8, 16, v207
    v_and_b32 v9, 0xffff0000, v207
    v_mul_f32 v10, s9, v8
    v_mul_f32 v11, s9, v9
    v_fma_f32 v12, v8, s9, -v10
    v_fma_f32 v13, v9, s9, -v11
    v_exp_f32 v10, v10
    v_exp_f32 v11, v11
    v_fmac_f32 v12, 0xb2a57060, v8
    v_fmac_f32 v13, 0xb2a57060, v9
    v_mul_f32 v12, s10, v12
    v_mul_f32 v13, s10, v13
    v_min_f32 v10, 0x7f7fffff, v10
    v_min_f32 v11, 0x7f7fffff, v11
    v_fmac_f32 v10, v10, v12
    v_fmac_f32 v11, v11, v13
    v_add_f32 v10, 1.0, v10
    v_add_f32 v11, 1.0, v11
    v_min_f32 v10, 0x7f7fffff, v10
    v_min_f32 v11, 0x7f7fffff, v11
    v_rcp_f32 v12, v10
    v_rcp_f32 v13, v11
    v_mul_f32 v14, v8, v12
    v_mul_f32 v15, v9, v13
    v_fma_f32 v8, -v14, v10, v8
    v_fma_f32 v9, -v15, v11, v9
    v_fmac_f32 v14, v8, v12
    v_fmac_f32 v15, v9, v13
    v_cvt_pk_bf16_f32 v207, v14, v15
    v_lshlrev_b32 v8, 16, v55
    v_and_b32 v9, 0xffff0000, v55
    v_mul_f32 v10, s9, v8
    v_mul_f32 v11, s9, v9
    v_fma_f32 v12, v8, s9, -v10
    v_fma_f32 v13, v9, s9, -v11
    v_exp_f32 v10, v10
    v_exp_f32 v11, v11
    v_fmac_f32 v12, 0xb2a57060, v8
    v_fmac_f32 v13, 0xb2a57060, v9
    v_mul_f32 v12, s10, v12
    v_mul_f32 v13, s10, v13
    v_min_f32 v10, 0x7f7fffff, v10
    v_min_f32 v11, 0x7f7fffff, v11
    v_fmac_f32 v10, v10, v12
    v_fmac_f32 v11, v11, v13
    v_add_f32 v10, 1.0, v10
    v_add_f32 v11, 1.0, v11
    v_min_f32 v10, 0x7f7fffff, v10
    v_min_f32 v11, 0x7f7fffff, v11
    v_rcp_f32 v12, v10
    v_rcp_f32 v13, v11
    v_mul_f32 v14, v8, v12
    v_mul_f32 v15, v9, v13
    v_fma_f32 v8, -v14, v10, v8
    v_fma_f32 v9, -v15, v11, v9
    v_fmac_f32 v14, v8, v12
    v_fmac_f32 v15, v9, v13
    v_cvt_pk_bf16_f32 v55, v14, v15
    v_mul_u32_u24 v8, 320, v5
    v_mul_u32_u24 v9, 20, v4
    v_add3_u32 v8, v8, v9, 0
    v_add_u32 v8, 122880, v8
    ds_write2_b32 v8, v204, v205 offset0:0 offset1:1
    ds_write2_b32 v8, v206, v207 offset0:2 offset1:3
    ds_write_b32 v8, v55 offset:16
    v_and_b32 v9, 3, v4
    v_mul_u32_u24 v9, 320, v9
    v_lshl_add_u32 v9, v5, 4, v9
    v_add_u32 v9, 122880, v9
    s_mov_b32 s56, 0x00f000f0
    s_mov_b32 s57, 0x00f000f0
    s_mov_b32 s58, 0x0f000f00
    s_mov_b32 s59, 0x0f000f00
    s_mov_b32 s64, 0xf000f000
    s_mov_b32 s65, 0xf000f000
    s_waitcnt lgkmcnt(0)
    ds_read_b128 v[160:163], v9 offset:0
    ds_read_b128 v[164:167], v9 offset:64
    ds_read_b128 v[168:171], v9 offset:128
    ds_read_b128 v[172:175], v9 offset:192
    ds_read_b128 v[176:179], v9 offset:256
    v_lshrrev_b32 v6, 2, v4
    v_and_b32 v7, 3, v4
    v_lshl_add_u32 v6, v5, 3, v6
    v_lshlrev_b32 v8, 7, v6
    v_lshl_add_u32 v8, v7, 3, v8
    v_lshlrev_b32 v53, 8, v6
    v_lshl_add_u32 v53, v7, 3, v53
    v_mov_b32 v10, 156352
    s_waitcnt vmcnt(2)
    s_add_u32 m0, s14, 2048
    s_nop 0
    buffer_load_dwordx4 v61, s[60:63], s13 offen nt lds
    s_add_u32 s13, s13, 49152
    s_add_u32 m0, s14, 3072
    s_nop 0
    buffer_load_dwordx4 v61, s[60:63], s13 offen nt lds
    s_add_u32 s13, s13, 49152
L_h_lpoll:
    ds_read_b32 v11, v10 offset:0
    s_waitcnt lgkmcnt(0)
    v_cmp_gt_u32 vcc, 7, v11
    s_cbranch_vccz L_h_lpoll_ok
    s_sleep 1
    s_sub_u32 s84, s84, 1
    s_cmp_lg_u32 s84, 0
    s_cbranch_scc1 L_h_lpoll
L_h_lpoll_ok:
    ds_read_b64_tr_b16 v[208:209], v8 offset:0
    ds_read_b64_tr_b16 v[210:211], v8 offset:512
    ds_read_b64_tr_b16 v[212:213], v8 offset:32
    ds_read_b64_tr_b16 v[214:215], v8 offset:544
    ds_read_b64_tr_b16 v[216:217], v8 offset:64
    ds_read_b64_tr_b16 v[218:219], v8 offset:576
    ds_read_b64_tr_b16 v[220:221], v8 offset:96
    ds_read_b64_tr_b16 v[222:223], v8 offset:608
    s_cmp_ge_u32 s89, 20
    s_cbranch_scc1 L_h_nof1
    s_cmp_ge_u32 s89, 10
    s_cselect_b32 s9, 10, 0
    s_cselect_b32 s10, 2, 0
    s_sub_u32 s9, s89, s9
    s_lshr_b32 s11, s9, 1
    s_and_b32 s9, s9, 1
    s_add_u32 s10, s10, s9
    s_lshl_b32 s9, s88, 2
    s_add_u32 s10, s10, s9
    s_lshl_b32 s10, s10, 2
    s_mul_i32 s11, s11, 6144
    s_add_u32 s11, s11, s10
    s_add_u32 s11, s11, 4096
    v_lshlrev_b32 v12, 7, v1
    v_mov_b32 v13, s85
    s_mov_b32 exec_lo, 0xffffffff
    s_mov_b32 exec_hi, 0xffff
    buffer_store_dword v13, v12, s[52:55], s11 offen sc1
    s_mov_b64 exec, -1
L_h_nof1:
    s_waitcnt lgkmcnt(0)
    ds_read_b64_tr_b16 v[224:225], v8 offset:4096
    ds_read_b64_tr_b16 v[226:227], v8 offset:4608
    ds_read_b64_tr_b16 v[228:229], v8 offset:4128
    ds_read_b64_tr_b16 v[230:231], v8 offset:4640
    ds_read_b64_tr_b16 v[232:233], v8 offset:4160
    ds_read_b64_tr_b16 v[234:235], v8 offset:4672
    ds_read_b64_tr_b16 v[236:237], v8 offset:4192
    ds_read_b64_tr_b16 v[238:239], v8 offset:4704
    v_mfma_f32_16x16x32_bf16 v[20:23], v[208:211], v[160:163], 0
    v_mfma_f32_16x16x32_bf16 v[24:27], v[212:215], v[160:163], 0
    v_mfma_f32_16x16x32_bf16 v[28:31], v[216:219], v[160:163], 0
    v_mfma_f32_16x16x32_bf16 v[32:35], v[220:223], v[160:163], 0
    s_waitcnt lgkmcnt(0)
    ds_read_b64_tr_b16 v[208:209], v8 offset:8192
    ds_read_b64_tr_b16 v[210:211], v8 offset:8704
    ds_read_b64_tr_b16 v[212:213], v8 offset:8224
    ds_read_b64_tr_b16 v[214:215], v8 offset:8736
    ds_read_b64_tr_b16 v[216:217], v8 offset:8256
    ds_read_b64_tr_b16 v[218:219], v8 offset:8768
    ds_read_b64_tr_b16 v[220:221], v8 offset:8288
    ds_read_b64_tr_b16 v[222:223], v8 offset:8800
    v_mfma_f32_16x16x32_bf16 v[20:23], v[224:227], v[164:167], v[20:23]
    v_mfma_f32_16x16x32_bf16 v[24:27], v[228:231], v[164:167], v[24:27]
    v_mfma_f32_16x16x32_bf16 v[28:31], v[232:235], v[164:167], v[28:31]
    v_mfma_f32_16x16x32_bf16 v[32:35], v[236:239], v[164:167], v[32:35]
    s_waitcnt lgkmcnt(0)
    ds_read_b64_tr_b16 v[224:225], v8 offset:12288
    ds_read_b64_tr_b16 v[226:227], v8 offset:12800
    ds_read_b64_tr_b16 v[228:229], v8 offset:12320
    ds_read_b64_tr_b16 v[230:231], v8 offset:12832
    ds_read_b64_tr_b16 v[232:233], v8 offset:12352
    ds_read_b64_tr_b16 v[234:235], v8 offset:12864
    ds_read_b64_tr_b16 v[236:237], v8 offset:12384
    ds_read_b64_tr_b16 v[238:239], v8 offset:12896
    v_mfma_f32_16x16x32_bf16 v[20:23], v[208:211], v[168:171], v[20:23]
    v_mfma_f32_16x16x32_bf16 v[24:27], v[212:215], v[168:171], v[24:27]
    v_mfma_f32_16x16x32_bf16 v[28:31], v[216:219], v[168:171], v[28:31]
    v_mfma_f32_16x16x32_bf16 v[32:35], v[220:223], v[168:171], v[32:35]
    s_waitcnt lgkmcnt(0)
    ds_read_b64_tr_b16 v[208:209], v8 offset:16384
    ds_read_b64_tr_b16 v[210:211], v8 offset:16896
    ds_read_b64_tr_b16 v[212:213], v8 offset:16416
    ds_read_b64_tr_b16 v[214:215], v8 offset:16928
    ds_read_b64_tr_b16 v[216:217], v8 offset:16448
    ds_read_b64_tr_b16 v[218:219], v8 offset:16960
    ds_read_b64_tr_b16 v[220:221], v8 offset:16480
    ds_read_b64_tr_b16 v[222:223], v8 offset:16992
    v_mfma_f32_16x16x32_bf16 v[20:23], v[224:227], v[172:175], v[20:23]
    v_mfma_f32_16x16x32_bf16 v[24:27], v[228:231], v[172:175], v[24:27]
    v_mfma_f32_16x16x32_bf16 v[28:31], v[232:235], v[172:175], v[28:31]
    v_mfma_f32_16x16x32_bf16 v[32:35], v[236:239], v[172:175], v[32:35]
    s_waitcnt lgkmcnt(0)
    v_mfma_f32_16x16x32_bf16 v[20:23], v[208:211], v[176:179], v[20:23]
    v_mfma_f32_16x16x32_bf16 v[24:27], v[212:215], v[176:179], v[24:27]
    v_mfma_f32_16x16x32_bf16 v[28:31], v[216:219], v[176:179], v[28:31]
    v_mfma_f32_16x16x32_bf16 v[32:35], v[220:223], v[176:179], v[32:35]
    v_and_b32 v9, 3, v4
    v_mul_u32_u24 v9, 15360, v9
    v_lshrrev_b32 v11, 2, v4
    v_lshl_add_u32 v9, v11, 6, v9
    v_lshl_add_u32 v9, v5, 4, v9
    s_mul_i32 s11, s88, 61440
    s_lshl_b32 s12, s89, 8
    s_add_u32 s11, s11, s12
    s_add_u32 s11, s11, 65536
    v_cndmask_b32 v36, v20, v24, s[56:57]
    v_cndmask_b32 v36, v36, v28, s[58:59]
    v_cndmask_b32 v36, v36, v32, s[64:65]
    v_cndmask_b32 v37, v21, v25, s[56:57]
    v_cndmask_b32 v37, v37, v29, s[58:59]
    v_cndmask_b32 v37, v37, v33, s[64:65]
    v_cndmask_b32 v38, v22, v26, s[56:57]
    v_cndmask_b32 v38, v38, v30, s[58:59]
    v_cndmask_b32 v38, v38, v34, s[64:65]
    v_cndmask_b32 v39, v23, v27, s[56:57]
    v_cndmask_b32 v39, v39, v31, s[58:59]
    v_cndmask_b32 v39, v39, v35, s[64:65]
    v_perm_b32 v36, v36, v39, s94
    v_perm_b32 v37, v37, v39, s95
    v_perm_b32 v38, v38, v39, s96
    v_mov_b32 v39, s85
    buffer_store_dwordx4 v[36:39], v9, s[52:55], s11 offen sc1
    v_and_b32 v6, 3, v4
    v_lshrrev_b32 v7, 2, v4
    v_mul_u32_u24 v8, 15360, v6
    v_lshl_add_u32 v8, v7, 6, v8
    v_lshl_add_u32 v8, v5, 4, v8
    s_lshl_b32 s13, s90, 9
    s_add_u32 s13, s13, 65536
    s_waitcnt lgkmcnt(0)
    s_lshl_b32 s9, s101, 7
    s_add_u32 s9, s9, 4096
    s_add_u32 s14, s42, s9
    s_addc_u32 s15, s43, 0
L_h_sp1:
    s_load_dwordx16 s[56:71], s[14:15], 0 glc
    s_waitcnt lgkmcnt(0)
    s_and_b64 vcc, s[56:57], s[58:59]
    s_or_b64 s[56:57], s[56:57], s[58:59]
    s_and_b64 vcc, vcc, s[60:61]
    s_or_b64 s[56:57], s[56:57], s[60:61]
    s_and_b64 vcc, vcc, s[62:63]
    s_or_b64 s[56:57], s[56:57], s[62:63]
    s_and_b64 vcc, vcc, s[64:65]
    s_or_b64 s[56:57], s[56:57], s[64:65]
    s_and_b64 vcc, vcc, s[66:67]
    s_or_b64 s[56:57], s[56:57], s[66:67]
    s_and_b64 vcc, vcc, s[68:69]
    s_or_b64 s[56:57], s[56:57], s[68:69]
    s_and_b64 vcc, vcc, s[70:71]
    s_or_b64 s[56:57], s[56:57], s[70:71]
    s_and_b32 vcc_lo, vcc_lo, vcc_hi
    s_or_b32 s56, s56, s57
    s_xor_b32 vcc_lo, vcc_lo, s85
    s_xor_b32 s56, s56, s85
    s_or_b32 s56, s56, vcc_lo
    s_cmp_eq_u32 s56, 0
    s_cbranch_scc1 L_h_sp1_ok
    s_sleep 1
    s_sub_u32 s84, s84, 1
    s_cmp_lg_u32 s84, 0
    s_cbranch_scc1 L_h_sp1
L_h_sp1_ok:
    s_mov_b32 s11, s13
    buffer_load_dwordx4 v[192:195], v8, s[52:55], s11 offen offset:0 sc1
    buffer_load_dwordx4 v[196:199], v8, s[52:55], s11 offen offset:256 sc1
    buffer_load_dwordx4 v[200:203], v8, s[52:55], s11 offen offset:2560 sc1
    buffer_load_dwordx4 v[204:207], v8, s[52:55], s11 offen offset:2816 sc1
    s_add_u32 s11, s11, 61440
    buffer_load_dwordx4 v[208:211], v8, s[52:55], s11 offen offset:0 sc1
    buffer_load_dwordx4 v[212:215], v8, s[52:55], s11 offen offset:256 sc1
    buffer_load_dwordx4 v[216:219], v8, s[52:55], s11 offen offset:2560 sc1
    buffer_load_dwordx4 v[220:223], v8, s[52:55], s11 offen offset:2816 sc1
    s_add_u32 s11, s11, 61440
    buffer_load_dwordx4 v[224:227], v8, s[52:55], s11 offen offset:0 sc1
    buffer_load_dwordx4 v[228:231], v8, s[52:55], s11 offen offset:256 sc1
    buffer_load_dwordx4 v[232:235], v8, s[52:55], s11 offen offset:2560 sc1
    buffer_load_dwordx4 v[236:239], v8, s[52:55], s11 offen offset:2816 sc1
    s_add_u32 s11, s11, 61440
    buffer_load_dwordx4 v[240:243], v8, s[52:55], s11 offen offset:0 sc1
    buffer_load_dwordx4 v[244:247], v8, s[52:55], s11 offen offset:256 sc1
    buffer_load_dwordx4 v[248:251], v8, s[52:55], s11 offen offset:2560 sc1
    buffer_load_dwordx4 v[252:255], v8, s[52:55], s11 offen offset:2816 sc1
    v_lshlrev_b32 v64, 16, v128
    v_and_b32 v65, 0xffff0000, v128
    v_lshlrev_b32 v66, 16, v129
    v_and_b32 v67, 0xffff0000, v129
    v_lshlrev_b32 v68, 16, v130
    v_and_b32 v69, 0xffff0000, v130
    v_lshlrev_b32 v70, 16, v131
    v_and_b32 v71, 0xffff0000, v131
    v_lshlrev_b32 v72, 16, v132
    v_and_b32 v73, 0xffff0000, v132
    v_lshlrev_b32 v74, 16, v133
    v_and_b32 v75, 0xffff0000, v133
    v_lshlrev_b32 v76, 16, v134
    v_and_b32 v77, 0xffff0000, v134
    v_lshlrev_b32 v78, 16, v135
    v_and_b32 v79, 0xffff0000, v135
    v_lshlrev_b32 v80, 16, v136
    v_and_b32 v81, 0xffff0000, v136
    v_lshlrev_b32 v82, 16, v137
    v_and_b32 v83, 0xffff0000, v137
    v_lshlrev_b32 v84, 16, v138
    v_and_b32 v85, 0xffff0000, v138
    v_lshlrev_b32 v86, 16, v139
    v_and_b32 v87, 0xffff0000, v139
    v_lshlrev_b32 v88, 16, v140
    v_and_b32 v89, 0xffff0000, v140
    v_lshlrev_b32 v90, 16, v141
    v_and_b32 v91, 0xffff0000, v141
    v_lshlrev_b32 v92, 16, v142
    v_and_b32 v93, 0xffff0000, v142
    v_lshlrev_b32 v94, 16, v143
    v_and_b32 v95, 0xffff0000, v143
    v_lshlrev_b32 v96, 16, v144
    v_and_b32 v97, 0xffff0000, v144
    v_lshlrev_b32 v98, 16, v145
    v_and_b32 v99, 0xffff0000, v145
    v_lshlrev_b32 v100, 16, v146
    v_and_b32 v101, 0xffff0000, v146
    v_lshlrev_b32 v102, 16, v147
    v_and_b32 v103, 0xffff0000, v147
    v_add_f32 v10, v64, v65
    v_add_f32 v10, v10, v66
    v_add_f32 v10, v10, v67
    v_add_f32 v10, v10, v68
    v_add_f32 v10, v10, v69
    v_add_f32 v10, v10, v70
    v_add_f32 v10, v10, v71
    v_add_f32 v10, v10, v72
    v_add_f32 v10, v10, v73
    v_add_f32 v10, v10, v74
    v_add_f32 v10, v10, v75
    v_add_f32 v10, v10, v76
    v_add_f32 v10, v10, v77
    v_add_f32 v10, v10, v78
    v_add_f32 v10, v10, v79
    v_add_f32 v10, v10, v80
    v_add_f32 v10, v10, v81
    v_add_f32 v10, v10, v82
    v_add_f32 v10, v10, v83
    v_add_f32 v10, v10, v84
    v_add_f32 v10, v10, v85
    v_add_f32 v10, v10, v86
    v_add_f32 v10, v10, v87
    v_add_f32 v10, v10, v88
    v_add_f32 v10, v10, v89
    v_add_f32 v10, v10, v90
    v_add_f32 v10, v10, v91
    v_add_f32 v10, v10, v92
    v_add_f32 v10, v10, v93
    v_add_f32 v10, v10, v94
    v_add_f32 v10, v10, v95
    v_add_f32 v10, v10, v96
    v_add_f32 v10, v10, v97
    v_add_f32 v10, v10, v98
    v_add_f32 v10, v10, v99
    v_add_f32 v10, v10, v100
    v_add_f32 v10, v10, v101
    v_add_f32 v10, v10, v102
    v_add_f32 v10, v10, v103
    s_nop 1
    v_add_f32_dpp v10, v10, v10 row_ror:4 row_mask:0xf bank_mask:0xf
    s_nop 1
    v_add_f32_dpp v10, v10, v10 row_ror:8 row_mask:0xf bank_mask:0xf
    v_mov_b32 v11, v10
    s_nop 1
    v_permlane16_swap_b32 v10, v11
    v_add_f32 v10, v10, v11
    v_mov_b32 v11, v10
    s_nop 1
    v_permlane32_swap_b32 v10, v11
    v_add_f32 v10, v10, v11
    v_mul_f32 v10, 0x3acccccd, v10
    v_sub_f32 v64, v64, v10
    v_sub_f32 v65, v65, v10
    v_sub_f32 v66, v66, v10
    v_sub_f32 v67, v67, v10
    v_sub_f32 v68, v68, v10
    v_sub_f32 v69, v69, v10
    v_sub_f32 v70, v70, v10
    v_sub_f32 v71, v71, v10
    v_sub_f32 v72, v72, v10
    v_sub_f32 v73, v73, v10
    v_sub_f32 v74, v74, v10
    v_sub_f32 v75, v75, v10
    v_sub_f32 v76, v76, v10
    v_sub_f32 v77, v77, v10
    v_sub_f32 v78, v78, v10
    v_sub_f32 v79, v79, v10
    v_sub_f32 v80, v80, v10
    v_sub_f32 v81, v81, v10
    v_sub_f32 v82, v82, v10
    v_sub_f32 v83, v83, v10
    v_sub_f32 v84, v84, v10
    v_sub_f32 v85, v85, v10
    v_sub_f32 v86, v86, v10
    v_sub_f32 v87, v87, v10
    v_sub_f32 v88, v88, v10
    v_sub_f32 v89, v89, v10
    v_sub_f32 v90, v90, v10
    v_sub_f32 v91, v91, v10
    v_sub_f32 v92, v92, v10
    v_sub_f32 v93, v93, v10
    v_sub_f32 v94, v94, v10
    v_sub_f32 v95, v95, v10
    v_sub_f32 v96, v96, v10
    v_sub_f32 v97, v97, v10
    v_sub_f32 v98, v98, v10
    v_sub_f32 v99, v99, v10
    v_sub_f32 v100, v100, v10
    v_sub_f32 v101, v101, v10
    v_sub_f32 v102, v102, v10
    v_sub_f32 v103, v103, v10
    v_mul_f32 v12, v64, v64
    v_fmac_f32 v12, v65, v65
    v_fmac_f32 v12, v66, v66
    v_fmac_f32 v12, v67, v67
    v_fmac_f32 v12, v68, v68
    v_fmac_f32 v12, v69, v69
    v_fmac_f32 v12, v70, v70
    v_fmac_f32 v12, v71, v71
    v_fmac_f32 v12, v72, v72
    v_fmac_f32 v12, v73, v73
    v_fmac_f32 v12, v74, v74
    v_fmac_f32 v12, v75, v75
    v_fmac_f32 v12, v76, v76
    v_fmac_f32 v12, v77, v77
    v_fmac_f32 v12, v78, v78
    v_fmac_f32 v12, v79, v79
    v_fmac_f32 v12, v80, v80
    v_fmac_f32 v12, v81, v81
    v_fmac_f32 v12, v82, v82
    v_fmac_f32 v12, v83, v83
    v_fmac_f32 v12, v84, v84
    v_fmac_f32 v12, v85, v85
    v_fmac_f32 v12, v86, v86
    v_fmac_f32 v12, v87, v87
    v_fmac_f32 v12, v88, v88
    v_fmac_f32 v12, v89, v89
    v_fmac_f32 v12, v90, v90
    v_fmac_f32 v12, v91, v91
    v_fmac_f32 v12, v92, v92
    v_fmac_f32 v12, v93, v93
    v_fmac_f32 v12, v94, v94
    v_fmac_f32 v12, v95, v95
    v_fmac_f32 v12, v96, v96
    v_fmac_f32 v12, v97, v97
    v_fmac_f32 v12, v98, v98
    v_fmac_f32 v12, v99, v99
    v_fmac_f32 v12, v100, v100
    v_fmac_f32 v12, v101, v101
    v_fmac_f32 v12, v102, v102
    v_fmac_f32 v12, v103, v103
    s_nop 1
    v_add_f32_dpp v12, v12, v12 row_ror:4 row_mask:0xf bank_mask:0xf
    s_nop 1
    v_add_f32_dpp v12, v12, v12 row_ror:8 row_mask:0xf bank_mask:0xf
    v_mov_b32 v11, v12
    s_nop 1
    v_permlane16_swap_b32 v12, v11
    v_add_f32 v12, v12, v11
    v_mov_b32 v11, v12
    s_nop 1
    v_permlane32_swap_b32 v12, v11
    v_add_f32 v12, v12, v11
    v_mul_f32 v12, 0x3acccccd, v12
    v_cvt_pk_bf16_f32 v11, v10, v12
    v_lshlrev_b32 v10, 16, v11
    v_and_b32 v12, 0xffff0000, v11
    v_add_f32 v12, 0x3727c5ac, v12
    v_cvt_pk_bf16_f32 v12, v12, v12
    v_and_b32 v12, 0xffff0000, v12
    v_sqrt_f32 v12, v12
    s_nop 0
    v_cvt_pk_bf16_f32 v12, v12, v12
    v_and_b32 v12, 0xffff0000, v12
    v_rcp_f32 v12, v12
    v_lshlrev_b32 v44, 16, v148
    v_and_b32 v45, 0xffff0000, v148
    v_lshlrev_b32 v46, 16, v149
    v_and_b32 v47, 0xffff0000, v149
    v_lshlrev_b32 v48, 16, v150
    v_and_b32 v49, 0xffff0000, v150
    v_lshlrev_b32 v50, 16, v151
    v_and_b32 v51, 0xffff0000, v151
    v_sub_f32 v44, v44, v10
    v_sub_f32 v45, v45, v10
    v_sub_f32 v46, v46, v10
    v_sub_f32 v47, v47, v10
    v_sub_f32 v48, v48, v10
    v_sub_f32 v49, v49, v10
    v_sub_f32 v50, v50, v10
    v_sub_f32 v51, v51, v10
    v_cvt_pk_bf16_f32 v11, v44, v45
    v_lshlrev_b32 v44, 16, v11
    v_and_b32 v45, 0xffff0000, v11
    v_cvt_pk_bf16_f32 v11, v46, v47
    v_lshlrev_b32 v46, 16, v11
    v_and_b32 v47, 0xffff0000, v11
    v_cvt_pk_bf16_f32 v11, v48, v49
    v_lshlrev_b32 v48, 16, v11
    v_and_b32 v49, 0xffff0000, v11
    v_cvt_pk_bf16_f32 v11, v50, v51
    v_lshlrev_b32 v50, 16, v11
    v_and_b32 v51, 0xffff0000, v11
    v_mul_f32 v44, v44, v12
    v_mul_f32 v45, v45, v12
    v_mul_f32 v46, v46, v12
    v_mul_f32 v47, v47, v12
    v_mul_f32 v48, v48, v12
    v_mul_f32 v49, v49, v12
    v_mul_f32 v50, v50, v12
    v_mul_f32 v51, v51, v12
    v_cvt_pk_bf16_f32 v11, v44, v45
    v_lshlrev_b32 v44, 16, v11
    v_and_b32 v45, 0xffff0000, v11
    v_cvt_pk_bf16_f32 v11, v46, v47
    v_lshlrev_b32 v46, 16, v11
    v_and_b32 v47, 0xffff0000, v11
    v_cvt_pk_bf16_f32 v11, v48, v49
    v_lshlrev_b32 v48, 16, v11
    v_and_b32 v49, 0xffff0000, v11
    v_cvt_pk_bf16_f32 v11, v50, v51
    v_lshlrev_b32 v50, 16, v11
    v_and_b32 v51, 0xffff0000, v11
    v_mov_b32 v10, 156352
    s_waitcnt vmcnt(16)
L_h_lpoll2:
    ds_read_b32 v11, v10 offset:4
    s_waitcnt lgkmcnt(0)
    v_cmp_gt_u32 vcc, 7, v11
    s_cbranch_vccz L_h_lpoll2_ok
    s_sleep 1
    s_sub_u32 s84, s84, 1
    s_cmp_lg_u32 s84, 0
    s_cbranch_scc1 L_h_lpoll2
L_h_lpoll2_ok:
    ds_read_b64_tr_b16 v[64:65], v53 offset:20480
    ds_read_b64_tr_b16 v[66:67], v53 offset:21504
    ds_read_b64_tr_b16 v[68:69], v53 offset:20512
    ds_read_b64_tr_b16 v[70:71], v53 offset:21536
    ds_read_b64_tr_b16 v[72:73], v53 offset:20544
    ds_read_b64_tr_b16 v[74:75], v53 offset:21568
    ds_read_b64_tr_b16 v[76:77], v53 offset:20576
    ds_read_b64_tr_b16 v[78:79], v53 offset:21600
    s_waitcnt lgkmcnt(4)
    ds_read_b64_tr_b16 v[80:81], v53 offset:20608
    ds_read_b64_tr_b16 v[82:83], v53 offset:21632
    ds_read_b64_tr_b16 v[84:85], v53 offset:20640
    ds_read_b64_tr_b16 v[86:87], v53 offset:21664
    ds_read_b64_tr_b16 v[88:89], v53 offset:20672
    ds_read_b64_tr_b16 v[90:91], v53 offset:21696
    ds_read_b64_tr_b16 v[92:93], v53 offset:20704
    ds_read_b64_tr_b16 v[94:95], v53 offset:21728
    s_waitcnt lgkmcnt(4)
    ds_read_b64_tr_b16 v[96:97], v53 offset:28672
    ds_read_b64_tr_b16 v[98:99], v53 offset:29696
    ds_read_b64_tr_b16 v[100:101], v53 offset:28704
    ds_read_b64_tr_b16 v[102:103], v53 offset:29728
    ds_read_b64_tr_b16 v[104:105], v53 offset:28736
    ds_read_b64_tr_b16 v[106:107], v53 offset:29760
    ds_read_b64_tr_b16 v[108:109], v53 offset:28768
    ds_read_b64_tr_b16 v[110:111], v53 offset:29792
    s_waitcnt lgkmcnt(4)
    ds_read_b64_tr_b16 v[112:113], v53 offset:28800
    ds_read_b64_tr_b16 v[114:115], v53 offset:29824
    ds_read_b64_tr_b16 v[116:117], v53 offset:28832
    ds_read_b64_tr_b16 v[118:119], v53 offset:29856
    ds_read_b64_tr_b16 v[120:121], v53 offset:28864
    ds_read_b64_tr_b16 v[122:123], v53 offset:29888
    ds_read_b64_tr_b16 v[124:125], v53 offset:28896
    ds_read_b64_tr_b16 v[126:127], v53 offset:29920
    s_waitcnt lgkmcnt(4)
    ds_read_b64_tr_b16 v[128:129], v53 offset:36864
    ds_read_b64_tr_b16 v[130:131], v53 offset:37888
    ds_read_b64_tr_b16 v[132:133], v53 offset:36896
    ds_read_b64_tr_b16 v[134:135], v53 offset:37920
    ds_read_b64_tr_b16 v[136:137], v53 offset:36928
    ds_read_b64_tr_b16 v[138:139], v53 offset:37952
    ds_read_b64_tr_b16 v[140:141], v53 offset:36960
    ds_read_b64_tr_b16 v[142:143], v53 offset:37984
    s_waitcnt lgkmcnt(4)
    ds_read_b64_tr_b16 v[144:145], v53 offset:36992
    ds_read_b64_tr_b16 v[146:147], v53 offset:38016
    ds_read_b64_tr_b16 v[148:149], v53 offset:37024
    ds_read_b64_tr_b16 v[150:151], v53 offset:38048
    ds_read_b64_tr_b16 v[152:153], v53 offset:37056
    ds_read_b64_tr_b16 v[154:155], v53 offset:38080
    ds_read_b64_tr_b16 v[156:157], v53 offset:37088
    ds_read_b64_tr_b16 v[158:159], v53 offset:38112
    s_waitcnt lgkmcnt(4)
    ds_read_b64_tr_b16 v[160:161], v53 offset:45056
    ds_read_b64_tr_b16 v[162:163], v53 offset:46080
    ds_read_b64_tr_b16 v[164:165], v53 offset:45088
    ds_read_b64_tr_b16 v[166:167], v53 offset:46112
    ds_read_b64_tr_b16 v[168:169], v53 offset:45120
    ds_read_b64_tr_b16 v[170:171], v53 offset:46144
    ds_read_b64_tr_b16 v[172:173], v53 offset:45152
    ds_read_b64_tr_b16 v[174:175], v53 offset:46176
    s_waitcnt lgkmcnt(4)
    ds_read_b64_tr_b16 v[176:177], v53 offset:45184
    ds_read_b64_tr_b16 v[178:179], v53 offset:46208
    ds_read_b64_tr_b16 v[180:181], v53 offset:45216
    ds_read_b64_tr_b16 v[182:183], v53 offset:46240
    ds_read_b64_tr_b16 v[184:185], v53 offset:45248
    ds_read_b64_tr_b16 v[186:187], v53 offset:46272
    ds_read_b64_tr_b16 v[188:189], v53 offset:45280
    ds_read_b64_tr_b16 v[190:191], v53 offset:46304
    s_waitcnt lgkmcnt(4)
    s_branch L_h_poll1c
L_h_poll1:
    s_mov_b32 s11, s13
    buffer_load_dwordx4 v[192:195], v8, s[52:55], s11 offen offset:0 sc1
    buffer_load_dwordx4 v[196:199], v8, s[52:55], s11 offen offset:256 sc1
    buffer_load_dwordx4 v[200:203], v8, s[52:55], s11 offen offset:2560 sc1
    buffer_load_dwordx4 v[204:207], v8, s[52:55], s11 offen offset:2816 sc1
    s_add_u32 s11, s11, 61440
    buffer_load_dwordx4 v[208:211], v8, s[52:55], s11 offen offset:0 sc1
    buffer_load_dwordx4 v[212:215], v8, s[52:55], s11 offen offset:256 sc1
    buffer_load_dwordx4 v[216:219], v8, s[52:55], s11 offen offset:2560 sc1
    buffer_load_dwordx4 v[220:223], v8, s[52:55], s11 offen offset:2816 sc1
    s_add_u32 s11, s11, 61440
    buffer_load_dwordx4 v[224:227], v8, s[52:55], s11 offen offset:0 sc1
    buffer_load_dwordx4 v[228:231], v8, s[52:55], s11 offen offset:256 sc1
    buffer_load_dwordx4 v[232:235], v8, s[52:55], s11 offen offset:2560 sc1
    buffer_load_dwordx4 v[236:239], v8, s[52:55], s11 offen offset:2816 sc1
    s_add_u32 s11, s11, 61440
    buffer_load_dwordx4 v[240:243], v8, s[52:55], s11 offen offset:0 sc1
    buffer_load_dwordx4 v[244:247], v8, s[52:55], s11 offen offset:256 sc1
    buffer_load_dwordx4 v[248:251], v8, s[52:55], s11 offen offset:2560 sc1
    buffer_load_dwordx4 v[252:255], v8, s[52:55], s11 offen offset:2816 sc1
L_h_poll1c:
    s_waitcnt vmcnt(0)
    v_xor_b32 v10, s85, v195
    v_xor_b32 v11, s85, v199
    v_or_b32 v10, v10, v11
    v_xor_b32 v11, s85, v203
    v_or_b32 v10, v10, v11
    v_xor_b32 v11, s85, v207
    v_or_b32 v10, v10, v11
    v_xor_b32 v11, s85, v211
    v_or_b32 v10, v10, v11
    v_xor_b32 v11, s85, v215
    v_or_b32 v10, v10, v11
    v_xor_b32 v11, s85, v219
    v_or_b32 v10, v10, v11
    v_xor_b32 v11, s85, v223
    v_or_b32 v10, v10, v11
    v_xor_b32 v11, s85, v227
    v_or_b32 v10, v10, v11
    v_xor_b32 v11, s85, v231
    v_or_b32 v10, v10, v11
    v_xor_b32 v11, s85, v235
    v_or_b32 v10, v10, v11
    v_xor_b32 v11, s85, v239
    v_or_b32 v10, v10, v11
    v_xor_b32 v11, s85, v243
    v_or_b32 v10, v10, v11
    v_xor_b32 v11, s85, v247
    v_or_b32 v10, v10, v11
    v_xor_b32 v11, s85, v251
    v_or_b32 v10, v10, v11
    v_xor_b32 v11, s85, v255
    v_or_b32 v10, v10, v11
    v_cmp_ne_u32 vcc, 0, v10
    s_cbranch_vccz L_ok_51
    s_sleep 2
    s_sub_u32 s84, s84, 1
    s_cmp_lg_u32 s84, 0
    s_cbranch_scc1 L_h_poll1
L_ok_51:
    s_mov_b32 s56, 0x00f000f0
    s_mov_b32 s57, 0x00f000f0
    s_mov_b32 s58, 0x0f000f00
    s_mov_b32 s59, 0x0f000f00
    s_mov_b32 s64, 0xf000f000
    s_mov_b32 s65, 0xf000f000
    v_perm_b32 v195, v192, v193, s97
    v_perm_b32 v195, v195, v194, s98
    v_perm_b32 v199, v196, v197, s97
    v_perm_b32 v199, v199, v198, s98
    v_perm_b32 v203, v200, v201, s97
    v_perm_b32 v203, v203, v202, s98
    v_perm_b32 v207, v204, v205, s97
    v_perm_b32 v207, v207, v206, s98
    v_perm_b32 v211, v208, v209, s97
    v_perm_b32 v211, v211, v210, s98
    v_perm_b32 v215, v212, v213, s97
    v_perm_b32 v215, v215, v214, s98
    v_perm_b32 v219, v216, v217, s97
    v_perm_b32 v219, v219, v218, s98
    v_perm_b32 v223, v220, v221, s97
    v_perm_b32 v223, v223, v222, s98
    v_perm_b32 v227, v224, v225, s97
    v_perm_b32 v227, v227, v226, s98
    v_perm_b32 v231, v228, v229, s97
    v_perm_b32 v231, v231, v230, s98
    v_perm_b32 v235, v232, v233, s97
    v_perm_b32 v235, v235, v234, s98
    v_perm_b32 v239, v236, v237, s97
    v_perm_b32 v239, v239, v238, s98
    v_perm_b32 v243, v240, v241, s97
    v_perm_b32 v243, v243, v242, s98
    v_perm_b32 v247, v244, v245, s97
    v_perm_b32 v247, v247, v246, s98
    v_perm_b32 v251, v248, v249, s97
    v_perm_b32 v251, v251, v250, s98
    v_perm_b32 v255, v252, v253, s97
    v_perm_b32 v255, v255, v254, s98
    v_pk_add_f32 v[192:193], v[192:193], v[208:209]
    v_pk_add_f32 v[224:225], v[224:225], v[240:241]
    v_pk_add_f32 v[194:195], v[194:195], v[210:211]
    v_pk_add_f32 v[226:227], v[226:227], v[242:243]
    v_pk_add_f32 v[196:197], v[196:197], v[212:213]
    v_pk_add_f32 v[228:229], v[228:229], v[244:245]
    v_pk_add_f32 v[198:199], v[198:199], v[214:215]
    v_pk_add_f32 v[230:231], v[230:231], v[246:247]
    v_pk_add_f32 v[200:201], v[200:201], v[216:217]
    v_pk_add_f32 v[232:233], v[232:233], v[248:249]
    v_pk_add_f32 v[202:203], v[202:203], v[218:219]
    v_pk_add_f32 v[234:235], v[234:235], v[250:251]
    v_pk_add_f32 v[204:205], v[204:205], v[220:221]
    v_pk_add_f32 v[236:237], v[236:237], v[252:253]
    v_pk_add_f32 v[206:207], v[206:207], v[222:223]
    v_pk_add_f32 v[238:239], v[238:239], v[254:255]
    v_pk_add_f32 v[192:193], v[192:193], v[224:225]
    v_pk_add_f32 v[194:195], v[194:195], v[226:227]
    v_pk_add_f32 v[196:197], v[196:197], v[228:229]
    v_pk_add_f32 v[198:199], v[198:199], v[230:231]
    v_pk_add_f32 v[200:201], v[200:201], v[232:233]
    v_pk_add_f32 v[202:203], v[202:203], v[234:235]
    v_pk_add_f32 v[204:205], v[204:205], v[236:237]
    v_pk_add_f32 v[206:207], v[206:207], v[238:239]
    v_cvt_pk_bf16_f32 v11, v192, v193
    v_lshlrev_b32 v192, 16, v11
    v_and_b32 v193, 0xffff0000, v11
    v_cvt_pk_bf16_f32 v11, v194, v195
    v_lshlrev_b32 v194, 16, v11
    v_and_b32 v195, 0xffff0000, v11
    v_cvt_pk_bf16_f32 v11, v196, v197
    v_lshlrev_b32 v196, 16, v11
    v_and_b32 v197, 0xffff0000, v11
    v_cvt_pk_bf16_f32 v11, v198, v199
    v_lshlrev_b32 v198, 16, v11
    v_and_b32 v199, 0xffff0000, v11
    v_cvt_pk_bf16_f32 v11, v200, v201
    v_lshlrev_b32 v200, 16, v11
    v_and_b32 v201, 0xffff0000, v11
    v_cvt_pk_bf16_f32 v11, v202, v203
    v_lshlrev_b32 v202, 16, v11
    v_and_b32 v203, 0xffff0000, v11
    v_cvt_pk_bf16_f32 v11, v204, v205
    v_lshlrev_b32 v204, 16, v11
    v_and_b32 v205, 0xffff0000, v11
    v_cvt_pk_bf16_f32 v11, v206, v207
    v_lshlrev_b32 v206, 16, v11
    v_and_b32 v207, 0xffff0000, v11
    v_add_f32 v200, 1.0, v200
    v_add_f32 v201, 1.0, v201
    v_add_f32 v202, 1.0, v202
    v_add_f32 v203, 1.0, v203
    v_add_f32 v204, 1.0, v204
    v_add_f32 v205, 1.0, v205
    v_add_f32 v206, 1.0, v206
    v_add_f32 v207, 1.0, v207
    v_cvt_pk_bf16_f32 v11, v200, v201
    v_lshlrev_b32 v200, 16, v11
    v_and_b32 v201, 0xffff0000, v11
    v_cvt_pk_bf16_f32 v11, v202, v203
    v_lshlrev_b32 v202, 16, v11
    v_and_b32 v203, 0xffff0000, v11
    v_cvt_pk_bf16_f32 v11, v204, v205
    v_lshlrev_b32 v204, 16, v11
    v_and_b32 v205, 0xffff0000, v11
    v_cvt_pk_bf16_f32 v11, v206, v207
    v_lshlrev_b32 v206, 16, v11
    v_and_b32 v207, 0xffff0000, v11
    v_mul_f32 v44, v44, v200
    v_mul_f32 v45, v45, v201
    v_mul_f32 v46, v46, v202
    v_mul_f32 v47, v47, v203
    v_mul_f32 v48, v48, v204
    v_mul_f32 v49, v49, v205
    v_mul_f32 v50, v50, v206
    v_mul_f32 v51, v51, v207
    v_cvt_pk_bf16_f32 v11, v44, v45
    v_lshlrev_b32 v44, 16, v11
    v_and_b32 v45, 0xffff0000, v11
    v_cvt_pk_bf16_f32 v11, v46, v47
    v_lshlrev_b32 v46, 16, v11
    v_and_b32 v47, 0xffff0000, v11
    v_cvt_pk_bf16_f32 v11, v48, v49
    v_lshlrev_b32 v48, 16, v11
    v_and_b32 v49, 0xffff0000, v11
    v_cvt_pk_bf16_f32 v11, v50, v51
    v_lshlrev_b32 v50, 16, v11
    v_and_b32 v51, 0xffff0000, v11
    v_add_f32 v44, v44, v192
    v_add_f32 v45, v45, v193
    v_add_f32 v46, v46, v194
    v_add_f32 v47, v47, v195
    v_add_f32 v48, v48, v196
    v_add_f32 v49, v49, v197
    v_add_f32 v50, v50, v198
    v_add_f32 v51, v51, v199
    v_cvt_pk_bf16_f32 v40, v44, v45
    v_cvt_pk_bf16_f32 v41, v46, v47
    v_cvt_pk_bf16_f32 v42, v48, v49
    v_cvt_pk_bf16_f32 v43, v50, v51
    v_lshlrev_b32 v8, 8, v6
    v_lshl_add_u32 v9, v5, 4, v8
    v_add_u32 v9, 156672, v9
    v_lshl_add_u32 v8, v7, 5, v8
    v_lshl_add_u32 v8, v5, 3, v8
    v_add_u32 v8, 156672, v8
    s_waitcnt lgkmcnt(0)
    ds_write_b64 v8, v[40:41]
    ds_write_b64 v8, v[42:43] offset:128
    s_waitcnt lgkmcnt(0)
    ds_read_b128 v[192:195], v9
    ds_read_b128 v[196:199], v9 offset:64
    ds_read_b128 v[200:203], v9 offset:128
    ds_read_b128 v[204:207], v9 offset:192
    s_waitcnt lgkmcnt(0)
    v_mfma_f32_16x16x32_bf16 v[20:23], v[64:67], v[192:195], 0
    v_mfma_f32_16x16x32_bf16 v[24:27], v[68:71], v[192:195], 0
    v_mfma_f32_16x16x32_bf16 v[28:31], v[72:75], v[192:195], 0
    v_mfma_f32_16x16x32_bf16 v[32:35], v[76:79], v[192:195], 0
    v_mfma_f32_16x16x32_bf16 v[36:39], v[80:83], v[192:195], 0
    v_mfma_f32_16x16x32_bf16 v[40:43], v[84:87], v[192:195], 0
    v_mfma_f32_16x16x32_bf16 v[44:47], v[88:91], v[192:195], 0
    v_mfma_f32_16x16x32_bf16 v[48:51], v[92:95], v[192:195], 0
    v_mfma_f32_16x16x32_bf16 v[20:23], v[96:99], v[196:199], v[20:23]
    v_mfma_f32_16x16x32_bf16 v[24:27], v[100:103], v[196:199], v[24:27]
    v_mfma_f32_16x16x32_bf16 v[28:31], v[104:107], v[196:199], v[28:31]
    v_mfma_f32_16x16x32_bf16 v[32:35], v[108:111], v[196:199], v[32:35]
    v_mfma_f32_16x16x32_bf16 v[36:39], v[112:115], v[196:199], v[36:39]
    v_mfma_f32_16x16x32_bf16 v[40:43], v[116:119], v[196:199], v[40:43]
    v_mfma_f32_16x16x32_bf16 v[44:47], v[120:123], v[196:199], v[44:47]
    v_mfma_f32_16x16x32_bf16 v[48:51], v[124:127], v[196:199], v[48:51]
    v_mfma_f32_16x16x32_bf16 v[20:23], v[128:131], v[200:203], v[20:23]
    v_mfma_f32_16x16x32_bf16 v[24:27], v[132:135], v[200:203], v[24:27]
    v_mfma_f32_16x16x32_bf16 v[28:31], v[136:139], v[200:203], v[28:31]
    v_mfma_f32_16x16x32_bf16 v[32:35], v[140:143], v[200:203], v[32:35]
    v_mfma_f32_16x16x32_bf16 v[36:39], v[144:147], v[200:203], v[36:39]
    v_mfma_f32_16x16x32_bf16 v[40:43], v[148:151], v[200:203], v[40:43]
    v_mfma_f32_16x16x32_bf16 v[44:47], v[152:155], v[200:203], v[44:47]
    v_mfma_f32_16x16x32_bf16 v[48:51], v[156:159], v[200:203], v[48:51]
    v_mfma_f32_16x16x32_bf16 v[20:23], v[160:163], v[204:207], v[20:23]
    v_mfma_f32_16x16x32_bf16 v[24:27], v[164:167], v[204:207], v[24:27]
    v_mfma_f32_16x16x32_bf16 v[28:31], v[168:171], v[204:207], v[28:31]
    v_mfma_f32_16x16x32_bf16 v[32:35], v[172:175], v[204:207], v[32:35]
    v_mfma_f32_16x16x32_bf16 v[36:39], v[176:179], v[204:207], v[36:39]
    v_mfma_f32_16x16x32_bf16 v[40:43], v[180:183], v[204:207], v[40:43]
    v_mfma_f32_16x16x32_bf16 v[44:47], v[184:187], v[204:207], v[44:47]
    v_mfma_f32_16x16x32_bf16 v[48:51], v[188:191], v[204:207], v[48:51]
    s_lshl_b32 s9, s91, 1
    s_mul_i32 s10, s9, 171
    s_lshr_b32 s10, s10, 9
    s_add_u32 s9, s9, 1
    s_mul_i32 s9, s9, 171
    s_lshr_b32 s9, s9, 9
    v_mov_b32 v8, s10
    v_mov_b32 v9, s9
    v_cndmask_b32 v8, v8, v9, s[74:75]
    v_mul_u32_u24 v9, 3, v8
    v_lshrrev_b32 v9, 1, v9
    v_sub_u32 v9, s91, v9
    s_lshl_b32 s9, s90, 1
    v_add_u32 v9, s9, v9
    v_and_b32 v10, 7, v1
    v_lshlrev_b32 v10, 2, v10
    v_and_b32 v11, 3, v8
    v_add_u32 v10, v10, v11
    v_lshrrev_b32 v11, 2, v8
    v_lshl_add_u32 v10, v10, 3, v11
    v_lshlrev_b32 v10, 7, v10
    v_lshl_add_u32 v10, v9, 2, v10
    v_mov_b32 v8, s85
    s_mov_b32 s9, 5963776
    s_mov_b32 exec_lo, 0xffff
    s_mov_b32 exec_hi, 0x0
    buffer_store_dword v8, v10, s[52:55], s9 offen sc1
    s_mov_b64 exec, -1
    v_mul_u32_u24 v9, 24576, v6
    v_lshl_add_u32 v9, v7, 6, v9
    v_lshl_add_u32 v9, v5, 4, v9
    s_mul_i32 s11, s90, 98304
    s_lshl_b32 s12, s91, 9
    s_add_u32 s11, s11, s12
    s_add_u32 s11, s11, 327680
    v_cndmask_b32 v208, v20, v24, s[56:57]
    v_cndmask_b32 v208, v208, v28, s[58:59]
    v_cndmask_b32 v208, v208, v32, s[64:65]
    v_cndmask_b32 v209, v21, v25, s[56:57]
    v_cndmask_b32 v209, v209, v29, s[58:59]
    v_cndmask_b32 v209, v209, v33, s[64:65]
    v_cndmask_b32 v210, v22, v26, s[56:57]
    v_cndmask_b32 v210, v210, v30, s[58:59]
    v_cndmask_b32 v210, v210, v34, s[64:65]
    v_cndmask_b32 v211, v23, v27, s[56:57]
    v_cndmask_b32 v211, v211, v31, s[58:59]
    v_cndmask_b32 v211, v211, v35, s[64:65]
    v_perm_b32 v208, v208, v211, s94
    v_perm_b32 v209, v209, v211, s95
    v_perm_b32 v210, v210, v211, s96
    v_mov_b32 v211, s85
    buffer_store_dwordx4 v[208:211], v9, s[52:55], s11 offen sc1
    v_cndmask_b32 v212, v36, v40, s[56:57]
    v_cndmask_b32 v212, v212, v44, s[58:59]
    v_cndmask_b32 v212, v212, v48, s[64:65]
    v_cndmask_b32 v213, v37, v41, s[56:57]
    v_cndmask_b32 v213, v213, v45, s[58:59]
    v_cndmask_b32 v213, v213, v49, s[64:65]
    v_cndmask_b32 v214, v38, v42, s[56:57]
    v_cndmask_b32 v214, v214, v46, s[58:59]
    v_cndmask_b32 v214, v214, v50, s[64:65]
    v_cndmask_b32 v215, v39, v43, s[56:57]
    v_cndmask_b32 v215, v215, v47, s[58:59]
    v_cndmask_b32 v215, v215, v51, s[64:65]
    v_perm_b32 v212, v212, v215, s94
    v_perm_b32 v213, v213, v215, s95
    v_perm_b32 v214, v214, v215, s96
    v_mov_b32 v215, s85
    buffer_store_dwordx4 v[212:215], v9, s[52:55], s11 offen offset:256 sc1
    v_mov_b32 v10, 156352
    v_mov_b32 v11, 1
    ds_write_b32 v10, v11 offset:12
    s_branch L_h_q
L_h_nounit2:
    v_mov_b32 v10, 156352
    v_mov_b32 v11, 1
    ds_write_b32 v10, v11 offset:12
L_h_q:
    v_min_u32 v8, 47, v1
    v_lshlrev_b32 v8, 4, v8
    s_mul_i32 s11, s5, 24576
    s_mul_i32 s12, s4, 768
    s_add_u32 s11, s11, s12
    s_add_u32 s11, s11, 327680
    s_waitcnt lgkmcnt(0)
    s_lshl_b32 s9, s2, 7
    s_add_u32 s9, s9, 5963776
    s_add_u32 s14, s42, s9
    s_addc_u32 s15, s43, 0
L_h_sp2:
    s_load_dwordx16 s[56:71], s[14:15], 0 glc
    s_waitcnt lgkmcnt(0)
    s_and_b64 vcc, s[56:57], s[58:59]
    s_or_b64 s[56:57], s[56:57], s[58:59]
    s_and_b64 vcc, vcc, s[60:61]
    s_or_b64 s[56:57], s[56:57], s[60:61]
    s_and_b64 vcc, vcc, s[62:63]
    s_or_b64 s[56:57], s[56:57], s[62:63]
    s_and_b64 vcc, vcc, s[64:65]
    s_or_b64 s[56:57], s[56:57], s[64:65]
    s_and_b32 vcc_lo, vcc_lo, vcc_hi
    s_or_b32 s56, s56, s57
    s_xor_b32 vcc_lo, vcc_lo, s85
    s_xor_b32 s56, s56, s85
    s_or_b32 s56, s56, vcc_lo
    s_cmp_eq_u32 s56, 0
    s_cbranch_scc1 L_h_sp2_ok
    s_sleep 1
    s_sub_u32 s84, s84, 1
    s_cmp_lg_u32 s84, 0
    s_cbranch_scc1 L_h_sp2
L_h_sp2_ok:
L_h_poll2:
    s_mov_b32 s12, s11
    buffer_load_dwordx4 v[20:23], v8, s[52:55], s12 offen sc1
    s_add_u32 s12, s12, 98304
    buffer_load_dwordx4 v[24:27], v8, s[52:55], s12 offen sc1
    s_add_u32 s12, s12, 98304
    buffer_load_dwordx4 v[28:31], v8, s[52:55], s12 offen sc1
    s_add_u32 s12, s12, 98304
    buffer_load_dwordx4 v[32:35], v8, s[52:55], s12 offen sc1
    s_add_u32 s12, s12, 98304
    buffer_load_dwordx4 v[36:39], v8, s[52:55], s12 offen sc1
    s_waitcnt vmcnt(0)
    v_xor_b32 v9, s85, v23
    v_xor_b32 v10, s85, v27
    v_or_b32 v9, v9, v10
    v_xor_b32 v10, s85, v31
    v_or_b32 v9, v9, v10
    v_xor_b32 v10, s85, v35
    v_or_b32 v9, v9, v10
    v_xor_b32 v10, s85, v39
    v_or_b32 v9, v9, v10
    v_cmp_ne_u32 vcc, 0, v9
    s_cbranch_vccz L_ok_52
    s_sleep 2
    s_sub_u32 s84, s84, 1
    s_cmp_lg_u32 s84, 0
    s_cbranch_scc1 L_h_poll2
L_ok_52:
    v_perm_b32 v23, v20, v21, s97
    v_perm_b32 v23, v23, v22, s98
    v_perm_b32 v27, v24, v25, s97
    v_perm_b32 v27, v27, v26, s98
    v_perm_b32 v31, v28, v29, s97
    v_perm_b32 v31, v31, v30, s98
    v_perm_b32 v35, v32, v33, s97
    v_perm_b32 v35, v35, v34, s98
    v_perm_b32 v39, v36, v37, s97
    v_perm_b32 v39, v39, v38, s98
    v_add_f32 v20, v20, v24
    v_add_f32 v28, v28, v32
    v_add_f32 v21, v21, v25
    v_add_f32 v29, v29, v33
    v_add_f32 v22, v22, v26
    v_add_f32 v30, v30, v34
    v_add_f32 v23, v23, v27
    v_add_f32 v31, v31, v35
    v_add_f32 v20, v20, v28
    v_add_f32 v21, v21, v29
    v_add_f32 v22, v22, v30
    v_add_f32 v23, v23, v31
    v_add_f32 v20, v20, v36
    v_add_f32 v21, v21, v37
    v_add_f32 v22, v22, v38
    v_add_f32 v23, v23, v39
    v_cvt_pk_bf16_f32 v10, v20, v21
    v_cvt_pk_bf16_f32 v11, v22, v23
    v_lshrrev_b32 v8, 1, v8
    v_add_u32 v8, 155648, v8
    ds_write_b64 v8, v[10:11]
L_h_qdone:
    v_mov_b32 v10, 156352
    v_mov_b32 v11, 1
    s_waitcnt lgkmcnt(0)
    ds_write_b32 v10, v11 offset:8
    s_setprio 0
    s_cmp_ge_u32 s2, 240
    s_cbranch_scc1 L_h_noconst
    v_mul_u32_u24 v13, 15360, v5
    v_lshrrev_b32 v14, 1, v4
    v_lshl_add_u32 v13, v14, 4, v13
    s_lshl_b32 s13, s100, 7
    s_add_u32 s13, s13, 70656
L_h_poll3:
    s_mov_b32 s11, s13
    buffer_load_dwordx4 v[192:195], v13, s[52:55], s11 offen sc1
    buffer_load_dwordx4 v[196:199], v13, s[52:55], s11 offen offset:2560 sc1
    s_add_u32 s12, s11, 5120
    buffer_load_dwordx4 v[200:203], v13, s[52:55], s12 offen sc1
    buffer_load_dwordx4 v[204:207], v13, s[52:55], s12 offen offset:2560 sc1
    s_add_u32 s11, s11, 61440
    buffer_load_dwordx4 v[208:211], v13, s[52:55], s11 offen sc1
    buffer_load_dwordx4 v[212:215], v13, s[52:55], s11 offen offset:2560 sc1
    s_add_u32 s12, s11, 5120
    buffer_load_dwordx4 v[216:219], v13, s[52:55], s12 offen sc1
    buffer_load_dwordx4 v[220:223], v13, s[52:55], s12 offen offset:2560 sc1
    s_add_u32 s11, s11, 61440
    buffer_load_dwordx4 v[224:227], v13, s[52:55], s11 offen sc1
    buffer_load_dwordx4 v[228:231], v13, s[52:55], s11 offen offset:2560 sc1
    s_add_u32 s12, s11, 5120
    buffer_load_dwordx4 v[232:235], v13, s[52:55], s12 offen sc1
    buffer_load_dwordx4 v[236:239], v13, s[52:55], s12 offen offset:2560 sc1
    s_add_u32 s11, s11, 61440
    buffer_load_dwordx4 v[240:243], v13, s[52:55], s11 offen sc1
    buffer_load_dwordx4 v[244:247], v13, s[52:55], s11 offen offset:2560 sc1
    s_add_u32 s12, s11, 5120
    buffer_load_dwordx4 v[248:251], v13, s[52:55], s12 offen sc1
    buffer_load_dwordx4 v[252:255], v13, s[52:55], s12 offen offset:2560 sc1
    s_waitcnt vmcnt(0)
    v_xor_b32 v10, s85, v195
    v_xor_b32 v11, s85, v199
    v_or_b32 v10, v10, v11
    v_xor_b32 v11, s85, v203
    v_or_b32 v10, v10, v11
    v_xor_b32 v11, s85, v207
    v_or_b32 v10, v10, v11
    v_xor_b32 v11, s85, v211
    v_or_b32 v10, v10, v11
    v_xor_b32 v11, s85, v215
    v_or_b32 v10, v10, v11
    v_xor_b32 v11, s85, v219
    v_or_b32 v10, v10, v11
    v_xor_b32 v11, s85, v223
    v_or_b32 v10, v10, v11
    v_xor_b32 v11, s85, v227
    v_or_b32 v10, v10, v11
    v_xor_b32 v11, s85, v231
    v_or_b32 v10, v10, v11
    v_xor_b32 v11, s85, v235
    v_or_b32 v10, v10, v11
    v_xor_b32 v11, s85, v239
    v_or_b32 v10, v10, v11
    v_xor_b32 v11, s85, v243
    v_or_b32 v10, v10, v11
    v_xor_b32 v11, s85, v247
    v_or_b32 v10, v10, v11
    v_xor_b32 v11, s85, v251
    v_or_b32 v10, v10, v11
    v_xor_b32 v11, s85, v255
    v_or_b32 v10, v10, v11
    v_cmp_ne_u32 vcc, 0, v10
    s_cbranch_vccz L_ok_53
    s_sleep 2
    s_sub_u32 s84, s84, 1
    s_cmp_lg_u32 s84, 0
    s_cbranch_scc1 L_h_poll3
L_ok_53:
    v_perm_b32 v195, v192, v193, s97
    v_perm_b32 v195, v195, v194, s98
    v_perm_b32 v199, v196, v197, s97
    v_perm_b32 v199, v199, v198, s98
    v_perm_b32 v203, v200, v201, s97
    v_perm_b32 v203, v203, v202, s98
    v_perm_b32 v207, v204, v205, s97
    v_perm_b32 v207, v207, v206, s98
    v_perm_b32 v211, v208, v209, s97
    v_perm_b32 v211, v211, v210, s98
    v_perm_b32 v215, v212, v213, s97
    v_perm_b32 v215, v215, v214, s98
    v_perm_b32 v219, v216, v217, s97
    v_perm_b32 v219, v219, v218, s98
    v_perm_b32 v223, v220, v221, s97
    v_perm_b32 v223, v223, v222, s98
    v_perm_b32 v227, v224, v225, s97
    v_perm_b32 v227, v227, v226, s98
    v_perm_b32 v231, v228, v229, s97
    v_perm_b32 v231, v231, v230, s98
    v_perm_b32 v235, v232, v233, s97
    v_perm_b32 v235, v235, v234, s98
    v_perm_b32 v239, v236, v237, s97
    v_perm_b32 v239, v239, v238, s98
    v_perm_b32 v243, v240, v241, s97
    v_perm_b32 v243, v243, v242, s98
    v_perm_b32 v247, v244, v245, s97
    v_perm_b32 v247, v247, v246, s98
    v_perm_b32 v251, v248, v249, s97
    v_perm_b32 v251, v251, v250, s98
    v_perm_b32 v255, v252, v253, s97
    v_perm_b32 v255, v255, v254, s98
    v_add_f32 v192, v192, v208
    v_add_f32 v224, v224, v240
    v_add_f32 v193, v193, v209
    v_add_f32 v225, v225, v241
    v_add_f32 v194, v194, v210
    v_add_f32 v226, v226, v242
    v_add_f32 v195, v195, v211
    v_add_f32 v227, v227, v243
    v_add_f32 v196, v196, v212
    v_add_f32 v228, v228, v244
    v_add_f32 v197, v197, v213
    v_add_f32 v229, v229, v245
    v_add_f32 v198, v198, v214
    v_add_f32 v230, v230, v246
    v_add_f32 v199, v199, v215
    v_add_f32 v231, v231, v247
    v_add_f32 v200, v200, v216
    v_add_f32 v232, v232, v248
    v_add_f32 v201, v201, v217
    v_add_f32 v233, v233, v249
    v_add_f32 v202, v202, v218
    v_add_f32 v234, v234, v250
    v_add_f32 v203, v203, v219
    v_add_f32 v235, v235, v251
    v_add_f32 v204, v204, v220
    v_add_f32 v236, v236, v252
    v_add_f32 v205, v205, v221
    v_add_f32 v237, v237, v253
    v_add_f32 v206, v206, v222
    v_add_f32 v238, v238, v254
    v_add_f32 v207, v207, v223
    v_add_f32 v239, v239, v255
    v_add_f32 v192, v192, v224
    v_add_f32 v193, v193, v225
    v_add_f32 v194, v194, v226
    v_add_f32 v195, v195, v227
    v_add_f32 v196, v196, v228
    v_add_f32 v197, v197, v229
    v_add_f32 v198, v198, v230
    v_add_f32 v199, v199, v231
    v_add_f32 v200, v200, v232
    v_add_f32 v201, v201, v233
    v_add_f32 v202, v202, v234
    v_add_f32 v203, v203, v235
    v_add_f32 v204, v204, v236
    v_add_f32 v205, v205, v237
    v_add_f32 v206, v206, v238
    v_add_f32 v207, v207, v239
    v_cndmask_b32 v208, v192, v194, s[72:73]
    v_cndmask_b32 v209, v193, v195, s[72:73]
    v_cndmask_b32 v210, v196, v198, s[72:73]
    v_cndmask_b32 v211, v197, v199, s[72:73]
    v_cndmask_b32 v212, v200, v202, s[72:73]
    v_cndmask_b32 v213, v201, v203, s[72:73]
    v_cndmask_b32 v214, v204, v206, s[72:73]
    v_cndmask_b32 v215, v205, v207, s[72:73]
    v_cvt_pk_bf16_f32 v11, v208, v209
    v_lshlrev_b32 v208, 16, v11
    v_and_b32 v209, 0xffff0000, v11
    v_cvt_pk_bf16_f32 v11, v212, v213
    v_lshlrev_b32 v212, 16, v11
    v_and_b32 v213, 0xffff0000, v11
    v_cvt_pk_bf16_f32 v11, v214, v215
    v_lshlrev_b32 v214, 16, v11
    v_and_b32 v215, 0xffff0000, v11
    v_cvt_pk_bf16_f32 v210, v210, v211
    v_add_f32 v212, 1.0, v212
    v_add_f32 v213, 1.0, v213
    v_cvt_pk_bf16_f32 v211, v212, v213
    v_lshlrev_b32 v212, 16, v211
    v_and_b32 v213, 0xffff0000, v211
    v_lshlrev_b32 v216, 16, v52
    v_and_b32 v217, 0xffff0000, v52
    v_lshlrev_b32 v8, 3, v1
    v_add_u32 v8, 157696, v8
    ds_write_b64 v8, v[208:209]
    ds_write_b64 v8, v[212:213] offset:512
    ds_write_b64 v8, v[216:217] offset:1024
    ds_write_b64 v8, v[214:215] offset:1536
    v_lshlrev_b32 v8, 2, v1
    v_add_u32 v8, 159744, v8
    ds_write_b32 v8, v211
    ds_write_b32 v8, v210 offset:256
L_h_noconst:
    s_waitcnt lgkmcnt(0)
    v_mov_b32 v10, 156352
    s_cmp_gt_u32 s3, 4
    s_cselect_b32 s9, 2, 1
    s_sub_u32 s9, s3, s9
    s_lshl_b32 s9, s9, 2
    s_mul_i32 s10, s3, 3072
    s_sub_u32 s10, s7, s10
    s_add_u32 s11, s9, 0
    s_mul_i32 s12, s11, 171
    s_lshr_b32 s12, s12, 9
    s_mul_i32 s26, s12, 24192
    s_lshl_b32 s27, s11, 7
    s_add_u32 s26, s26, s27
    s_add_u32 s26, s26, s10
    s_lshl_b32 s27, s11, 10
    s_add_u32 s15, s27, 73728
    s_add_u32 s27, s27, 98304
    s_cmp_eq_u32 s3, 4
    s_cselect_b32 s16, 0x10000000, s26
    s_cselect_b32 s20, 160768, s15
    s_cselect_b32 s64, 160768, s27
    s_add_u32 s11, s9, 1
    s_mul_i32 s12, s11, 171
    s_lshr_b32 s12, s12, 9
    s_mul_i32 s26, s12, 24192
    s_lshl_b32 s27, s11, 7
    s_add_u32 s26, s26, s27
    s_add_u32 s26, s26, s10
    s_lshl_b32 s27, s11, 10
    s_add_u32 s15, s27, 73728
    s_add_u32 s27, s27, 98304
    s_cmp_eq_u32 s3, 4
    s_cselect_b32 s17, 0x10000000, s26
    s_cselect_b32 s21, 160768, s15
    s_cselect_b32 s65, 160768, s27
    s_add_u32 s11, s9, 2
    s_mul_i32 s12, s11, 171
    s_lshr_b32 s12, s12, 9
    s_mul_i32 s26, s12, 24192
    s_lshl_b32 s27, s11, 7
    s_add_u32 s26, s26, s27
    s_add_u32 s26, s26, s10
    s_lshl_b32 s27, s11, 10
    s_add_u32 s15, s27, 73728
    s_add_u32 s27, s27, 98304
    s_cmp_eq_u32 s3, 4
    s_cselect_b32 s18, 0x10000000, s26
    s_cselect_b32 s22, 160768, s15
    s_cselect_b32 s66, 160768, s27
    s_add_u32 s11, s9, 3
    s_mul_i32 s12, s11, 171
    s_lshr_b32 s12, s12, 9
    s_mul_i32 s26, s12, 24192
    s_lshl_b32 s27, s11, 7
    s_add_u32 s26, s26, s27
    s_add_u32 s26, s26, s10
    s_lshl_b32 s27, s11, 10
    s_add_u32 s15, s27, 73728
    s_add_u32 s27, s27, 98304
    s_cmp_eq_u32 s3, 4
    s_cselect_b32 s19, 0x10000000, s26
    s_cselect_b32 s23, 160768, s15
    s_cselect_b32 s67, 160768, s27
    s_mul_i32 s9, s2, 6554
    s_lshr_b32 s9, s9, 16
    s_mul_i32 s10, s9, 10
    s_sub_u32 s10, s2, s10
    s_lshl_b32 s9, s9, 8
    s_and_b32 s12, s3, 3
    s_lshl_b32 s11, s12, 6
    s_add_u32 s9, s9, s11
    s_mul_i32 s9, s9, 1280
    s_lshl_b32 s10, s10, 7
    s_add_u32 s68, s9, s10
    v_lshrrev_b32 v59, 3, v1
    v_mul_u32_u24 v59, 1280, v59
    v_and_b32 v60, 7, v1
    v_lshl_add_u32 v59, v60, 4, v59
    v_mul_u32_u24 v60, 3072, v5
    v_lshl_add_u32 v60, v4, 4, v60
    v_lshlrev_b32 v62, 4, v1
    s_lshl_b32 s9, s100, 5
    s_lshl_b32 s10, s12, 3
    s_add_u32 s9, s9, s10
    s_mul_i32 s9, s9, 3072
    s_lshl_b32 s10, s99, 8
    s_add_u32 s69, s9, s10
    s_sub_u32 s11, s2, 144
    s_mul_i32 s11, s11, 20480
    s_mul_i32 s71, s12, 5120
    s_add_u32 s70, s11, s71
    s_lshr_b32 s9, s2, 3
    s_lshl_b32 s9, s9, 7
    s_add_u32 s9, s9, 6078464
    s_add_u32 s34, s42, s9
    s_addc_u32 s35, s43, 0
    s_and_b32 s10, s2, 7
    s_lshl_b32 s10, s10, 2
    s_add_u32 s36, s9, s10
    s_lshl_b32 s37, s85, 8
    s_add_u32 s9, s37, 3
    v_mov_b32 v61, s9
    v_add_u32 v8, 73728, v62
L_h_hk:
    ds_read_b32 v11, v10 offset:16
    s_waitcnt lgkmcnt(0)
    v_cmp_gt_u32 vcc, 7, v11
    s_cbranch_vccz L_h_hk_ok
    s_sleep 1
    s_sub_u32 s84, s84, 1
    s_cmp_lg_u32 s84, 0
    s_cbranch_scc1 L_h_hk
L_h_hk_ok:
    ds_read_b128 v[64:67], v8 offset:0
    ds_read_b128 v[68:71], v8 offset:1024
    ds_read_b128 v[72:75], v8 offset:2048
    ds_read_b128 v[76:79], v8 offset:3072
    ds_read_b128 v[80:83], v8 offset:4096
    ds_read_b128 v[84:87], v8 offset:5120
    ds_read_b128 v[88:91], v8 offset:6144
    ds_read_b128 v[92:95], v8 offset:7168
    s_waitcnt lgkmcnt(0)
    ds_read_b128 v[96:99], v8 offset:8192
    ds_read_b128 v[100:103], v8 offset:9216
    ds_read_b128 v[104:107], v8 offset:10240
    ds_read_b128 v[108:111], v8 offset:11264
    ds_read_b128 v[112:115], v8 offset:12288
    ds_read_b128 v[116:119], v8 offset:13312
    ds_read_b128 v[120:123], v8 offset:14336
    ds_read_b128 v[124:127], v8 offset:15360
    s_waitcnt lgkmcnt(0)
    ds_read_b128 v[128:131], v8 offset:16384
    ds_read_b128 v[132:135], v8 offset:17408
    ds_read_b128 v[136:139], v8 offset:18432
    ds_read_b128 v[140:143], v8 offset:19456
    ds_read_b128 v[144:147], v8 offset:20480
    ds_read_b128 v[148:151], v8 offset:21504
    ds_read_b128 v[152:155], v8 offset:22528
    ds_read_b128 v[156:159], v8 offset:23552
    s_waitcnt lgkmcnt(0)
L_h_hv:
    ds_read_b32 v11, v10 offset:20
    s_waitcnt lgkmcnt(0)
    v_cmp_gt_u32 vcc, 7, v11
    s_cbranch_vccz L_h_hv_ok
    s_sleep 1
    s_sub_u32 s84, s84, 1
    s_cmp_lg_u32 s84, 0
    s_cbranch_scc1 L_h_hv
L_h_hv_ok:
    ds_read_b128 v[160:163], v8 offset:24576
    ds_read_b128 v[164:167], v8 offset:25600
    ds_read_b128 v[168:171], v8 offset:26624
    ds_read_b128 v[172:175], v8 offset:27648
    ds_read_b128 v[176:179], v8 offset:28672
    ds_read_b128 v[180:183], v8 offset:29696
    ds_read_b128 v[184:187], v8 offset:30720
    ds_read_b128 v[188:191], v8 offset:31744
    s_waitcnt lgkmcnt(0)
    ds_read_b128 v[192:195], v8 offset:32768
    ds_read_b128 v[196:199], v8 offset:33792
    ds_read_b128 v[200:203], v8 offset:34816
    ds_read_b128 v[204:207], v8 offset:35840
    ds_read_b128 v[208:211], v8 offset:36864
    ds_read_b128 v[212:215], v8 offset:37888
    ds_read_b128 v[216:219], v8 offset:38912
    ds_read_b128 v[220:223], v8 offset:39936
    s_waitcnt lgkmcnt(0)
    ds_read_b128 v[224:227], v8 offset:40960
    ds_read_b128 v[228:231], v8 offset:41984
    ds_read_b128 v[232:235], v8 offset:43008
    ds_read_b128 v[236:239], v8 offset:44032
    ds_read_b128 v[240:243], v8 offset:45056
    ds_read_b128 v[244:247], v8 offset:46080
    ds_read_b128 v[248:251], v8 offset:47104
    ds_read_b128 v[252:255], v8 offset:48128
    s_waitcnt lgkmcnt(0)
    s_branch L_attB
L_tail:
    v_lshrrev_b32 v6, 3, v4
    v_mul_u32_u24 v6, 768, v6
    v_and_b32 v7, 7, v4
    v_lshl_add_u32 v6, v7, 5, v6
    v_and_b32 v7, 1, v5
    v_lshl_add_u32 v6, v7, 4, v6
    s_mul_i32 s8, s3, 1536
    s_add_u32 s8, s8, 122880
    v_add_u32 v6, s8, v6
    v_mov_b32 v17, 156352
    s_nop 3
    s_mov_b64 exec, s[82:83]
    ds_write_b128 v6, v[20:23]
    ds_write_b128 v6, v[24:27] offset:256
    ds_write_b128 v6, v[28:31] offset:512
    s_mov_b64 exec, -1
    s_cmp_eq_u32 s3, 7
    s_cbranch_scc0 L_t_notk
    s_waitcnt lgkmcnt(0)
    s_and_b32 s36, s36, 255
    s_add_u32 s36, s36, 1
    v_mov_b32 v7, s36
    ds_write_b32 v17, v7 offset:24
L_t_notk:
    s_waitcnt lgkmcnt(0)
    s_barrier
    s_cmp_ge_u32 s3, 3
    s_cbranch_scc1 L_t_nos1
    v_mov_b32 v6, 156160
    ds_read_b128 v[20:23], v6
    ds_read_b128 v[24:27], v6 offset:16
    ds_read_b128 v[28:31], v6 offset:32
    ds_read_b128 v[32:35], v6 offset:48
    v_lshlrev_b32 v7, 2, v0
    v_add_u32 v6, 122880, v7
    ds_read_b32 v64, v6 offset:0
    ds_read_b32 v65, v6 offset:768
    ds_read_b32 v66, v6 offset:1536
    ds_read_b32 v67, v6 offset:2304
    ds_read_b32 v68, v6 offset:3072
    ds_read_b32 v69, v6 offset:3840
    ds_read_b32 v70, v6 offset:4608
    ds_read_b32 v71, v6 offset:5376
    ds_read_b32 v72, v6 offset:6144
    ds_read_b32 v73, v6 offset:6912
    ds_read_b32 v74, v6 offset:7680
    ds_read_b32 v75, v6 offset:8448
    ds_read_b32 v76, v6 offset:9216
    ds_read_b32 v77, v6 offset:9984
    ds_read_b32 v78, v6 offset:10752
    ds_read_b32 v79, v6 offset:11520
    s_lshl_b32 s8, s5, 1
    s_add_u32 s8, s8, s6
    s_mul_i32 s8, s8, 96
    s_mul_i32 s9, s4, 3
    s_add_u32 s8, s8, s9
    s_add_u32 s8, s8, s3
    s_mul_i32 s8, s8, 384
    s_add_u32 s8, s8, 1310720
    v_lshlrev_b32 v7, 2, v1
    s_add_u32 s9, s9, s3
    s_lshr_b32 s12, s9, 2
    s_mul_i32 s12, s12, 1280
    s_and_b32 s9, s9, 3
    s_lshl_b32 s9, s9, 5
    s_add_u32 s12, s12, s9
    s_lshl_b32 s9, s5, 3
    s_add_u32 s12, s12, s9
    s_lshl_b32 s9, s6, 2
    s_add_u32 s12, s12, s9
    s_add_u32 s12, s12, 5996544
    v_lshlrev_b32 v16, 7, v1
    v_mov_b32 v11, s85
    s_mov_b32 exec_lo, 0x3ff
    s_mov_b32 exec_hi, 0x0
    buffer_store_dword v11, v16, s[52:55], s12 offen sc1
    s_mov_b64 exec, -1
    s_waitcnt lgkmcnt(15)
    v_max3_f32 v8, v20, v22, v24
    v_max3_f32 v8, v8, v26, v28
    v_max3_f32 v8, v8, v30, v32
    v_max_f32 v8, v8, v34
    v_sub_f32 v20, v20, v8
    v_sub_f32 v22, v22, v8
    v_sub_f32 v24, v24, v8
    v_sub_f32 v26, v26, v8
    v_sub_f32 v28, v28, v8
    v_sub_f32 v30, v30, v8
    v_sub_f32 v32, v32, v8
    v_sub_f32 v34, v34, v8
    v_mul_f32 v20, 0x3fb8aa3b, v20
    v_mul_f32 v22, 0x3fb8aa3b, v22
    v_mul_f32 v24, 0x3fb8aa3b, v24
    v_mul_f32 v26, 0x3fb8aa3b, v26
    v_mul_f32 v28, 0x3fb8aa3b, v28
    v_mul_f32 v30, 0x3fb8aa3b, v30
    v_mul_f32 v32, 0x3fb8aa3b, v32
    v_mul_f32 v34, 0x3fb8aa3b, v34
    v_exp_f32 v20, v20
    v_exp_f32 v22, v22
    v_exp_f32 v24, v24
    v_exp_f32 v26, v26
    v_exp_f32 v28, v28
    v_exp_f32 v30, v30
    v_exp_f32 v32, v32
    v_exp_f32 v34, v34
    s_waitcnt lgkmcnt(0)
    v_add_f32 v64, v64, v65
    v_add_f32 v66, v66, v67
    v_add_f32 v68, v68, v69
    v_add_f32 v70, v70, v71
    v_add_f32 v72, v72, v73
    v_add_f32 v74, v74, v75
    v_add_f32 v76, v76, v77
    v_add_f32 v78, v78, v79
    v_mul_f32 v12, v20, v64
    v_mul_f32 v9, v20, v21
    v_fmac_f32 v12, v22, v66
    v_fmac_f32 v9, v22, v23
    v_fmac_f32 v12, v24, v68
    v_fmac_f32 v9, v24, v25
    v_fmac_f32 v12, v26, v70
    v_fmac_f32 v9, v26, v27
    v_fmac_f32 v12, v28, v72
    v_fmac_f32 v9, v28, v29
    v_fmac_f32 v12, v30, v74
    v_fmac_f32 v9, v30, v31
    v_fmac_f32 v12, v32, v76
    v_fmac_f32 v9, v32, v33
    v_fmac_f32 v12, v34, v78
    v_fmac_f32 v9, v34, v35
    v_mov_b32 v10, 0
    v_mov_b32 v11, s85
    v_mov_b32_dpp v13, v12 quad_perm:[1,1,1,1] row_mask:0xf bank_mask:0xf
    v_mov_b32_dpp v14, v12 quad_perm:[2,2,2,2] row_mask:0xf bank_mask:0xf
    v_mov_b32_dpp v15, v12 quad_perm:[3,3,3,3] row_mask:0xf bank_mask:0xf
    v_perm_b32 v12, v12, v15, s94
    v_perm_b32 v13, v13, v15, s95
    v_perm_b32 v14, v14, v15, s96
    v_mov_b32 v15, s85
    s_mov_b32 exec_lo, 0x11111111
    s_mov_b32 exec_hi, 0x11111111
    buffer_store_dwordx4 v[12:15], v7, s[52:55], s8 offen sc1
    s_mov_b32 exec_lo, 0x1
    s_mov_b32 exec_hi, 0x0
    buffer_store_dwordx4 v[8:11], v7, s[52:55], s8 offen offset:256 sc1
    s_mov_b64 exec, -1
L_t_nos1:
    ds_read_b32 v18, v17 offset:24
    s_and_b32 s8, s3, 3
    s_cmp_lt_u32 s3, 4
    s_cselect_b32 s26, 0, 150
    s_cselect_b32 s27, 73728, 0
    s_cselect_b32 s15, -28672, 0
    s_add_u32 s15, s15, 135168
    s_add_u32 s26, s26, 45
    s_waitcnt lgkmcnt(0)
    v_readfirstlane_b32 s37, v18
    s_barrier
    s_mov_b32 s56, s24
    s_mov_b32 s57, s25
    s_mov_b32 s58, 7864320
    s_mov_b32 s59, 0x20000
    s_sub_u32 s37, s37, 1
    s_cmp_ge_u32 s37, 195
    s_cselect_b32 s101, 1, 0
    s_add_u32 s35, s37, 45
    s_cmp_lt_u32 s37, 45
    s_cselect_b32 s36, s37, s35
    s_cmp_lt_u32 s3, 4
    s_cselect_b32 s35, s35, s36
    s_mov_b32 s34, 0
    s_cmp_ge_u32 s37, s26
    s_cbranch_scc1 L_t_nowo
    s_mov_b32 s34, 1
    s_mul_i32 s9, s35, 6554
    s_lshr_b32 s9, s9, 16
    s_mul_i32 s10, s9, 10
    s_sub_u32 s10, s35, s10
    s_lshl_b32 s11, s9, 2
    s_add_u32 s11, s11, s8
    s_mul_i32 s68, s11, 81920
    s_lshl_b32 s12, s10, 7
    s_add_u32 s68, s68, s12
    s_lshl_b32 s12, s8, 13
    s_add_u32 s27, s27, s12
    s_add_u32 m0, s27, 0
    s_nop 0
    buffer_load_dwordx4 v59, s[56:59], s68 offen nt lds
    s_add_u32 s68, s68, 10240
    s_add_u32 m0, s27, 1024
    s_nop 0
    buffer_load_dwordx4 v59, s[56:59], s68 offen nt lds
    s_add_u32 s68, s68, 10240
    s_add_u32 m0, s27, 2048
    s_nop 0
    buffer_load_dwordx4 v59, s[56:59], s68 offen nt lds
    s_add_u32 s68, s68, 10240
    s_add_u32 m0, s27, 3072
    s_nop 0
    buffer_load_dwordx4 v59, s[56:59], s68 offen nt lds
    s_add_u32 s68, s68, 10240
    s_add_u32 m0, s27, 4096
    s_nop 0
    buffer_load_dwordx4 v59, s[56:59], s68 offen nt lds
    s_add_u32 s68, s68, 10240
    s_add_u32 m0, s27, 5120
    s_nop 0
    buffer_load_dwordx4 v59, s[56:59], s68 offen nt lds
    s_add_u32 s68, s68, 10240
    s_add_u32 m0, s27, 6144
    s_nop 0
    buffer_load_dwordx4 v59, s[56:59], s68 offen nt lds
    s_add_u32 s68, s68, 10240
    s_add_u32 m0, s27, 7168
    s_nop 0
    buffer_load_dwordx4 v59, s[56:59], s68 offen nt lds
L_t_nowo:
    s_barrier
    s_cmp_ge_u32 s3, 4
    s_cbranch_scc1 L_t_now1
    s_cmp_ge_u32 s2, 240
    s_cbranch_scc1 L_t_now1
    s_mov_b32 s60, s28
    s_mov_b32 s61, s29
    s_mov_b32 s62, 1966080
    s_mov_b32 s63, 0x20000
    s_mov_b32 s64, s30
    s_mov_b32 s65, s31
    s_mov_b32 s66, 1966080
    s_mov_b32 s67, 0x20000
    s_lshl_b32 s12, s3, 11
    s_add_u32 m0, s12, 32768
    s_nop 0
    buffer_load_dwordx4 v60, s[60:63], s69 offen nt lds
    s_add_u32 m0, s12, 40960
    s_nop 0
    buffer_load_dwordx4 v60, s[64:67], s69 offen nt lds
    s_add_u32 s69, s69, 12288
    s_add_u32 m0, s12, 33792
    s_nop 0
    buffer_load_dwordx4 v60, s[60:63], s69 offen nt lds
    s_add_u32 m0, s12, 41984
    s_nop 0
    buffer_load_dwordx4 v60, s[64:67], s69 offen nt lds
    s_cmp_lt_u32 s2, 144
    s_cbranch_scc1 L_t_now1
    s_cmp_eq_u32 s101, 0
    s_cbranch_scc1 L_t_now1
    s_mov_b32 s56, s32
    s_mov_b32 s57, s33
    s_mov_b32 s58, 1966080
    s_mov_b32 s59, 0x20000
    s_add_u32 m0, s71, 53248
    s_nop 0
    buffer_load_dwordx4 v62, s[56:59], s70 offen nt lds
    s_add_u32 s70, s70, 1024
    s_add_u32 m0, s71, 54272
    s_nop 0
    buffer_load_dwordx4 v62, s[56:59], s70 offen nt lds
    s_add_u32 s70, s70, 1024
    s_add_u32 m0, s71, 55296
    s_nop 0
    buffer_load_dwordx4 v62, s[56:59], s70 offen nt lds
    s_add_u32 s70, s70, 1024
    s_add_u32 m0, s71, 56320
    s_nop 0
    buffer_load_dwordx4 v62, s[56:59], s70 offen nt lds
    s_add_u32 s70, s70, 1024
    s_add_u32 m0, s71, 57344
    s_nop 0
    buffer_load_dwordx4 v62, s[56:59], s70 offen nt lds
L_t_now1:
    v_lshrrev_b32 v6, 2, v4
    v_and_b32 v7, 3, v4
    v_lshl_add_u32 v16, v5, 3, v6
    v_lshlrev_b32 v16, 8, v16
    v_lshl_add_u32 v16, v7, 3, v16
    s_lshl_b32 s12, s3, 5
    s_add_u32 s12, s12, 32768
    v_add_u32 v16, s12, v16
    v_and_b32 v19, 7, v4
    v_lshlrev_b32 v19, 6, v19
    v_lshl_add_u32 v19, v5, 4, v19
    v_add_u32 v19, 159744, v19
    ds_read_b128 v[188:191], v19
    v_lshlrev_b32 v185, 7, v7
    v_lshl_add_u32 v185, v5, 5, v185
    v_lshl_add_u32 v185, v6, 3, v185
    v_add_u32 v19, 157696, v185
    ds_read_b64 v[176:177], v19
    ds_read_b64 v[178:179], v19 offset:512
    ds_read_b64 v[180:181], v19 offset:1024
    v_add_u32 v186, 143360, v185
    s_lshl_b32 s12, s99, 3
    s_add_u32 s12, s12, s3
    s_mul_i32 s12, s12, 20
    s_add_u32 s12, s12, s100
    s_lshl_b32 s66, s12, 10
    s_add_u32 s66, s66, 3014656
    s_lshl_b32 s60, s12, 9
    s_add_u32 s60, s60, 1851392
    s_lshl_b32 s61, s12, 6
    s_add_u32 s61, s61, 2834432
    v_lshlrev_b32 v182, 4, v1
    v_add_u32 v192, s60, v182
    v_and_b32 v193, 3, v1
    v_lshlrev_b32 v193, 4, v193
    v_add_u32 v193, s61, v193
    v_cndmask_b32 v192, v192, v193, s[92:93]
    s_lshr_b32 s62, s100, 1
    s_mul_i32 s62, s62, 24
    s_mul_i32 s12, s3, 6
    s_add_u32 s62, s62, s12
    s_lshl_b32 s62, s62, 10
    s_and_b32 s12, s100, 1
    s_lshl_b32 s12, s12, 9
    s_add_u32 s62, s62, s12
    s_add_u32 s62, s62, 1605632
    s_add_u32 s63, s62, 4096
    v_lshrrev_b32 v183, 5, v1
    v_and_b32 v19, 31, v1
    v_lshlrev_b32 v184, 10, v183
    v_lshl_add_u32 v184, v19, 4, v184
    v_lshlrev_b32 v183, 9, v183
    v_lshl_add_u32 v183, v19, 2, v183
    s_lshl_b32 s12, s3, 10
    s_add_u32 s12, s12, 143360
    v_add_u32 v183, s12, v183
    s_lshl_b32 s64, s2, 8
    s_lshl_b32 s12, s3, 6
    s_add_u32 s64, s64, s12
    s_add_u32 s64, s64, 6094848
    s_mov_b32 s65, 0
    v_mov_b32 v187, v16
    s_cmp_eq_u32 s34, 1
    s_cbranch_scc1 L_wo
    s_waitcnt vmcnt(0)
    s_cmp_ge_u32 s3, 4
    s_cbranch_scc1 L_w1s_55
    v_mov_b32 v121, 1
    s_mov_b32 exec_lo, 0x1
    s_mov_b32 exec_hi, 0x0
    ds_add_u32 v17, v121 offset:40
    s_mov_b64 exec, -1
L_w1s_55:
    s_branch L_wo_done
L_wo:
    v_lshrrev_b32 v6, 2, v4
    v_and_b32 v7, 3, v4
    v_lshl_add_u32 v6, v5, 2, v6
    v_lshlrev_b32 v6, 7, v6
    v_lshl_add_u32 v6, v7, 3, v6
    v_add_u32 v6, s27, v6
    v_and_b32 v12, 7, v4
    v_lshrrev_b32 v7, 3, v4
    v_mul_u32_u24 v9, 36864, v12
    v_lshl_add_u32 v8, v7, 6, v9
    v_lshl_add_u32 v8, v5, 4, v8
    s_mul_i32 s11, s11, 384
    s_add_u32 s11, s11, 1310720
    v_lshrrev_b32 v10, 1, v5
    v_lshlrev_b32 v10, 10, v10
    v_lshl_add_u32 v10, v4, 4, v10
    v_and_b32 v11, 1, v5
    v_lshl_add_u32 v10, v11, 3, v10
    s_lshl_b32 s13, s8, 11
    s_add_u32 s13, s13, s15
    v_add_u32 v10, s13, v10
    v_lshlrev_b32 v13, 2, v1
    s_lshl_b32 s13, s8, 8
    s_add_u32 s12, s13, s15
    v_add_u32 v14, s12, v13
    s_lshl_b32 s36, s10, 9
    s_mul_i32 s12, s9, 43
    s_lshr_b32 s12, s12, 8
    s_mul_i32 s37, s12, 40
    s_lshl_b32 s12, s9, 2
    s_add_u32 s37, s37, s12
    s_add_u32 s36, s36, s37
    s_add_u32 s36, s36, 6094848
    v_lshrrev_b32 v15, 1, v1
    v_mul_u32_u24 v15, 5120, v15
    v_and_b32 v16, 1, v1
    v_lshl_add_u32 v15, v16, 8, v15
    v_mov_b32 v16, s85
    s_lshr_b32 s12, s3, 2
    s_lshl_b32 s12, s12, 2
    s_add_u32 s12, s12, 156384
    v_mov_b32 v18, s12
    v_mov_b32 v19, 1
    s_mul_i32 s10, s10, 24
    s_add_u32 s10, s10, s9
    s_lshl_b32 s10, s10, 10
    s_add_u32 s10, s10, s13
    s_add_u32 s10, s10, 1605632
    s_lshl_b32 s9, s35, 7
    s_lshl_b32 s12, s8, 5
    s_add_u32 s9, s9, s12
    s_add_u32 s9, s9, 5996544
    s_add_u32 s14, s42, s9
    s_addc_u32 s15, s43, 0
L_wo_sp:
    s_load_dwordx8 s[16:23], s[14:15], 0 glc
    s_waitcnt lgkmcnt(0)
    s_and_b64 vcc, s[16:17], s[18:19]
    s_or_b64 s[16:17], s[16:17], s[18:19]
    s_and_b64 vcc, vcc, s[20:21]
    s_or_b64 s[16:17], s[16:17], s[20:21]
    s_and_b64 vcc, vcc, s[22:23]
    s_or_b64 s[16:17], s[16:17], s[22:23]
    s_and_b32 vcc_lo, vcc_lo, vcc_hi
    s_or_b32 s16, s16, s17
    s_xor_b32 vcc_lo, vcc_lo, s85
    s_xor_b32 s16, s16, s85
    s_or_b32 s16, s16, vcc_lo
    s_cmp_eq_u32 s16, 0
    s_cbranch_scc1 L_wo_sp_ok
    s_sub_u32 s84, s84, 1
    s_cmp_lg_u32 s84, 0
    s_cbranch_scc1 L_wo_sp
L_wo_sp_ok:
L_wo_poll:
    buffer_load_dwordx4 v[96:99], v8, s[52:55], s11 offen sc1
    buffer_load_dwordx4 v[100:103], v8, s[52:55], s11 offen offset:128 sc1
    buffer_load_dwordx4 v[104:107], v9, s[52:55], s11 offen offset:256 sc1
    s_waitcnt vmcnt(3)
    ds_read_b64_tr_b16 v[64:65], v6 offset:0
    ds_read_b64_tr_b16 v[66:67], v6 offset:4096
    ds_read_b64_tr_b16 v[68:69], v6 offset:32
    ds_read_b64_tr_b16 v[70:71], v6 offset:4128
    ds_read_b64_tr_b16 v[72:73], v6 offset:64
    ds_read_b64_tr_b16 v[74:75], v6 offset:4160
    ds_read_b64_tr_b16 v[76:77], v6 offset:96
    ds_read_b64_tr_b16 v[78:79], v6 offset:4192
    ds_read_b64_tr_b16 v[80:81], v6 offset:2048
    ds_read_b64_tr_b16 v[82:83], v6 offset:6144
    ds_read_b64_tr_b16 v[84:85], v6 offset:2080
    ds_read_b64_tr_b16 v[86:87], v6 offset:6176
    ds_read_b64_tr_b16 v[88:89], v6 offset:2112
    ds_read_b64_tr_b16 v[90:91], v6 offset:6208
    ds_read_b64_tr_b16 v[92:93], v6 offset:2144
    ds_read_b64_tr_b16 v[94:95], v6 offset:6240
    s_waitcnt vmcnt(0)
    v_xor_b32 v11, s85, v99
    v_xor_b32 v12, s85, v103
    v_or_b32 v11, v11, v12
    v_xor_b32 v12, s85, v107
    v_or_b32 v11, v11, v12
    v_cmp_ne_u32 vcc, 0, v11
    s_cbranch_vccz L_ok_56
    s_sub_u32 s84, s84, 1
    s_cmp_lg_u32 s84, 0
    s_cbranch_scc1 L_wo_poll
L_ok_56:
    s_mov_b32 exec_lo, 0x1
    s_mov_b32 exec_hi, 0x0
    ds_add_rtn_u32 v120, v18, v19 offset:16
    s_mov_b64 exec, -1
    v_mov_b32_dpp v106, v104 quad_perm:[1,0,3,2] row_mask:0xf bank_mask:0xf
    v_mov_b32_dpp v107, v105 quad_perm:[1,0,3,2] row_mask:0xf bank_mask:0xf
    v_max_f32 v12, v104, v106
    v_sub_f32 v104, v104, v12
    v_sub_f32 v106, v106, v12
    v_mul_f32 v104, 0x3fb8aa3b, v104
    v_mul_f32 v106, 0x3fb8aa3b, v106
    v_exp_f32 v104, v104
    v_exp_f32 v106, v106
    v_perm_b32 v99, v96, v97, s97
    v_perm_b32 v99, v99, v98, s98
    v_perm_b32 v103, v100, v101, s97
    v_perm_b32 v103, v103, v102, s98
    v_mul_f32 v105, v105, v104
    v_fmac_f32 v105, v107, v106
    v_rcp_f32 v105, v105
    s_nop 0
    v_mul_f32 v104, v104, v105
    v_mul_f32 v96, v96, v104
    v_mul_f32 v97, v97, v104
    v_mul_f32 v98, v98, v104
    v_mul_f32 v99, v99, v104
    v_mul_f32 v100, v100, v104
    v_mul_f32 v101, v101, v104
    v_mul_f32 v102, v102, v104
    v_mul_f32 v103, v103, v104
    v_add_f32_dpp v96, v96, v96 quad_perm:[1,0,3,2] row_mask:0xf bank_mask:0xf
    v_add_f32_dpp v97, v97, v97 quad_perm:[1,0,3,2] row_mask:0xf bank_mask:0xf
    v_add_f32_dpp v98, v98, v98 quad_perm:[1,0,3,2] row_mask:0xf bank_mask:0xf
    v_add_f32_dpp v99, v99, v99 quad_perm:[1,0,3,2] row_mask:0xf bank_mask:0xf
    v_add_f32_dpp v100, v100, v100 quad_perm:[1,0,3,2] row_mask:0xf bank_mask:0xf
    v_add_f32_dpp v101, v101, v101 quad_perm:[1,0,3,2] row_mask:0xf bank_mask:0xf
    v_add_f32_dpp v102, v102, v102 quad_perm:[1,0,3,2] row_mask:0xf bank_mask:0xf
    v_add_f32_dpp v103, v103, v103 quad_perm:[1,0,3,2] row_mask:0xf bank_mask:0xf
    v_cvt_pk_bf16_f32 v108, v96, v97
    v_cvt_pk_bf16_f32 v109, v98, v99
    v_cvt_pk_bf16_f32 v110, v100, v101
    v_cvt_pk_bf16_f32 v111, v102, v103
    s_waitcnt lgkmcnt(0)
    s_nop 0
    v_mfma_f32_16x16x32_bf16 v[20:23], v[108:111], v[64:67], 0
    v_mfma_f32_16x16x32_bf16 v[24:27], v[108:111], v[80:83], 0
    v_mfma_f32_16x16x32_bf16 v[28:31], v[108:111], v[68:71], 0
    v_mfma_f32_16x16x32_bf16 v[32:35], v[108:111], v[84:87], 0
    v_mfma_f32_16x16x32_bf16 v[36:39], v[108:111], v[72:75], 0
    v_mfma_f32_16x16x32_bf16 v[40:43], v[108:111], v[88:91], 0
    v_mfma_f32_16x16x32_bf16 v[44:47], v[108:111], v[76:79], 0
    v_mfma_f32_16x16x32_bf16 v[48:51], v[108:111], v[92:95], 0
    s_nop 1
    v_cndmask_b32 v112, v20, v24, s[92:93]
    v_cndmask_b32 v113, v22, v26, s[92:93]
    ds_write_b64 v10, v[112:113] offset:0
    v_cndmask_b32 v114, v28, v32, s[92:93]
    v_cndmask_b32 v115, v30, v34, s[92:93]
    ds_write_b64 v10, v[114:115] offset:256
    v_cndmask_b32 v116, v36, v40, s[92:93]
    v_cndmask_b32 v117, v38, v42, s[92:93]
    ds_write_b64 v10, v[116:117] offset:512
    v_cndmask_b32 v118, v44, v48, s[92:93]
    v_cndmask_b32 v119, v46, v50, s[92:93]
    ds_write_b64 v10, v[118:119] offset:768
    s_waitcnt lgkmcnt(0)
    v_readfirstlane_b32 s12, v120
    s_cmp_eq_u32 s12, 3
    s_cbranch_scc0 L_af_57
    s_mov_b32 exec_lo, 0xffffff
    s_mov_b32 exec_hi, 0x0
    buffer_store_dword v16, v15, s[52:55], s36 offen sc1
    s_mov_b64 exec, -1
L_af_57:
    s_mov_b32 exec_lo, 0x1
    s_mov_b32 exec_hi, 0x0
    ds_add_u32 v18, v19
    s_mov_b64 exec, -1
L_wo_gs:
    ds_read_b32 v11, v18
    ds_read_b32 v20, v14 offset:0
    ds_read_b32 v21, v14 offset:1024
    ds_read_b32 v22, v14 offset:2048
    ds_read_b32 v23, v14 offset:3072
    ds_read_b32 v24, v14 offset:4096
    ds_read_b32 v25, v14 offset:5120
    ds_read_b32 v26, v14 offset:6144
    ds_read_b32 v27, v14 offset:7168
    s_waitcnt lgkmcnt(8)
    v_cmp_gt_u32 vcc, 4, v11
    s_cbranch_vccz L_wo_gs_ok
    s_sub_u32 s84, s84, 1
    s_cmp_lg_u32 s84, 0
    s_cbranch_scc1 L_wo_gs
L_wo_gs_ok:
    s_waitcnt lgkmcnt(0)
    v_add_f32 v20, v20, v21
    v_add_f32 v22, v22, v23
    v_add_f32 v24, v24, v25
    v_add_f32 v26, v26, v27
    v_add_f32 v20, v20, v22
    v_add_f32 v24, v24, v26
    v_add_f32 v20, v20, v24
    s_nop 1
    v_mov_b32_dpp v21, v20 quad_perm:[1,1,1,1] row_mask:0xf bank_mask:0xf
    v_mov_b32_dpp v22, v20 quad_perm:[2,2,2,2] row_mask:0xf bank_mask:0xf
    v_mov_b32_dpp v23, v20 quad_perm:[3,3,3,3] row_mask:0xf bank_mask:0xf
    v_perm_b32 v20, v20, v23, s94
    v_perm_b32 v21, v21, v23, s95
    v_perm_b32 v22, v22, v23, s96
    v_mov_b32 v23, s85
    s_mov_b32 exec_lo, 0x11111111
    s_mov_b32 exec_hi, 0x11111111
    buffer_store_dwordx4 v[20:23], v13, s[52:55], s10 offen sc1
    s_mov_b64 exec, -1
    s_cmp_ge_u32 s3, 4
    s_cbranch_scc1 L_w1s_58
    v_mov_b32 v121, 1
    s_mov_b32 exec_lo, 0x1
    s_mov_b32 exec_hi, 0x0
    ds_add_u32 v17, v121 offset:40
    s_mov_b64 exec, -1
L_w1s_58:
L_wo_done:
    s_cmp_ge_u32 s2, 240
    s_cbranch_scc1 L_end
    s_cmp_lt_u32 s3, 4
    s_cbranch_scc1 L_wdl0
    s_cmp_lt_u32 s2, 144
    s_cbranch_scc1 L_wdl0
    s_cmp_ge_u32 s2, 240
    s_cbranch_scc1 L_wdl0
    s_cmp_eq_u32 s101, 1
    s_cbranch_scc1 L_wdl0
    s_mov_b32 s56, s32
    s_mov_b32 s57, s33
    s_mov_b32 s58, 1966080
    s_mov_b32 s59, 0x20000
    s_add_u32 m0, s71, 53248
    s_nop 0
    buffer_load_dwordx4 v62, s[56:59], s70 offen nt lds
    s_add_u32 s70, s70, 1024
    s_add_u32 m0, s71, 54272
    s_nop 0
    buffer_load_dwordx4 v62, s[56:59], s70 offen nt lds
    s_add_u32 s70, s70, 1024
    s_add_u32 m0, s71, 55296
    s_nop 0
    buffer_load_dwordx4 v62, s[56:59], s70 offen nt lds
    s_add_u32 s70, s70, 1024
    s_add_u32 m0, s71, 56320
    s_nop 0
    buffer_load_dwordx4 v62, s[56:59], s70 offen nt lds
    s_add_u32 s70, s70, 1024
    s_add_u32 m0, s71, 57344
    s_nop 0
    buffer_load_dwordx4 v62, s[56:59], s70 offen nt lds
L_wdl0:
L_g23_59:
    ds_read_b32 v19, v17 offset:40
    ds_read_b64_tr_b16 v[168:169], v187
    ds_read_b64_tr_b16 v[170:171], v187 offset:1024
    ds_read_b64_tr_b16 v[172:173], v187 offset:8192
    ds_read_b64_tr_b16 v[174:175], v187 offset:9216
    s_waitcnt lgkmcnt(0)
    v_cmp_gt_u32 vcc, 4, v19
    s_cbranch_vccz L_g23_59_ok
    s_sleep 1
    s_sub_u32 s84, s84, 1
    s_cmp_lg_u32 s84, 0
    s_cbranch_scc1 L_g23_59
L_g23_59_ok:
    v_mfma_f32_16x16x32_bf16 v[24:27], v[188:191], v[168:171], 0
    v_mfma_f32_16x16x32_bf16 v[28:31], v[188:191], v[172:175], 0
    s_nop 7
    v_cndmask_b32 v24, v24, v28, s[92:93]
    v_cndmask_b32 v25, v25, v29, s[92:93]
    v_cndmask_b32 v26, v26, v30, s[92:93]
    v_cndmask_b32 v27, v27, v31, s[92:93]
    v_perm_b32 v24, v24, v27, s94
    v_perm_b32 v25, v25, v27, s95
    v_perm_b32 v26, v26, v27, s96
    v_mov_b32 v27, s85
    buffer_store_dwordx4 v[24:27], v182, s[52:55], s66 offen sc1
    s_cmp_ge_u32 s3, 4
    s_cbranch_scc1 L_s1_b3
L_s1_g:
    s_waitcnt lgkmcnt(0)
    s_add_u32 s14, s42, s64
    s_addc_u32 s15, s43, 0
L_s1_sp:
    s_load_dwordx8 s[16:23], s[14:15], 0 glc
    s_waitcnt lgkmcnt(0)
    s_and_b64 vcc, s[16:17], s[18:19]
    s_or_b64 s[16:17], s[16:17], s[18:19]
    s_and_b64 vcc, vcc, s[20:21]
    s_or_b64 s[16:17], s[16:17], s[20:21]
    s_and_b32 vcc_lo, vcc_lo, vcc_hi
    s_or_b32 s16, s16, s17
    s_xor_b32 vcc_lo, vcc_lo, s85
    s_xor_b32 s16, s16, s85
    s_or_b32 s16, s16, vcc_lo
    s_cmp_eq_u32 s16, 0
    s_cbranch_scc1 L_s1_sp_ok
    s_sleep 2
    s_sub_u32 s84, s84, 1
    s_cmp_lg_u32 s84, 0
    s_cbranch_scc1 L_s1_sp
L_s1_sp_ok:
L_s1_poll:
    buffer_load_dwordx4 v[96:99], v184, s[52:55], s62 offen sc1
    buffer_load_dwordx4 v[100:103], v184, s[52:55], s62 offen offset:2048 sc1
    buffer_load_dwordx4 v[104:107], v184, s[52:55], s63 offen sc1
    s_waitcnt vmcnt(0)
    v_xor_b32 v12, s85, v99
    v_xor_b32 v13, s85, v103
    v_or_b32 v12, v12, v13
    v_xor_b32 v13, s85, v107
    v_or_b32 v12, v12, v13
    v_cmp_ne_u32 vcc, 0, v12
    s_cbranch_vccz L_ok_60
    s_sleep 2
    s_sub_u32 s84, s84, 1
    s_cmp_lg_u32 s84, 0
    s_cbranch_scc1 L_s1_poll
L_ok_60:
    v_perm_b32 v99, v96, v97, s97
    v_perm_b32 v99, v99, v98, s98
    v_perm_b32 v103, v100, v101, s97
    v_perm_b32 v103, v103, v102, s98
    v_perm_b32 v107, v104, v105, s97
    v_perm_b32 v107, v107, v106, s98
    v_add_f32 v96, v96, v100
    v_add_f32 v97, v97, v101
    v_add_f32 v98, v98, v102
    v_add_f32 v99, v99, v103
    v_add_f32 v96, v96, v104
    v_add_f32 v97, v97, v105
    v_add_f32 v98, v98, v106
    v_add_f32 v99, v99, v107
    ds_write_b32 v183, v96 offset:0
    ds_write_b32 v183, v97 offset:128
    ds_write_b32 v183, v98 offset:256
    ds_write_b32 v183, v99 offset:384
L_s1_b3:
    s_sub_u32 s26, s2, 144
    s_lshl_b32 s26, s26, 1
    s_add_u32 s26, s26, s3
    s_sub_u32 s26, s26, 6
    s_mul_i32 s26, s26, 10240
    s_add_u32 s26, s26, 3014656
    s_cmp_ge_u32 s3, 6
    s_cselect_b32 s27, 1, 0
    s_cmp_ge_u32 s2, 144
    s_cselect_b32 s27, s27, 0
    v_mov_b32 v8, v182
    v_mov_b32 v18, v185
    v_lshrrev_b32 v6, 2, v4
    v_and_b32 v7, 3, v4
    s_waitcnt lgkmcnt(0)
    s_barrier
    ds_read_b64 v[96:97], v186 offset:0
    ds_read_b64 v[98:99], v186 offset:512
    ds_read_b64 v[100:101], v186 offset:1024
    ds_read_b64 v[102:103], v186 offset:1536
    ds_read_b64 v[104:105], v186 offset:2048
    ds_read_b64 v[106:107], v186 offset:2560
    ds_read_b64 v[108:109], v186 offset:3072
    ds_read_b64 v[110:111], v186 offset:3584
    s_cmp_eq_u32 s27, 0
    s_cbranch_scc1 L_s1_nost
    s_mov_b32 s12, s26
    buffer_load_dwordx4 v[128:131], v8, s[52:55], s12 offen offset:0 sc1
    buffer_load_dwordx4 v[132:135], v8, s[52:55], s12 offen offset:1024 sc1
    buffer_load_dwordx4 v[136:139], v8, s[52:55], s12 offen offset:2048 sc1
    buffer_load_dwordx4 v[140:143], v8, s[52:55], s12 offen offset:3072 sc1
    s_add_u32 s12, s12, 4096
    buffer_load_dwordx4 v[144:147], v8, s[52:55], s12 offen offset:0 sc1
    buffer_load_dwordx4 v[148:151], v8, s[52:55], s12 offen offset:1024 sc1
    buffer_load_dwordx4 v[152:155], v8, s[52:55], s12 offen offset:2048 sc1
    buffer_load_dwordx4 v[156:159], v8, s[52:55], s12 offen offset:3072 sc1
    s_add_u32 s12, s12, 4096
    buffer_load_dwordx4 v[160:163], v8, s[52:55], s12 offen offset:0 sc1
    buffer_load_dwordx4 v[164:167], v8, s[52:55], s12 offen offset:1024 sc1
L_s1_nost:
    s_waitcnt lgkmcnt(0)
    v_pk_add_f32 v[96:97], v[96:97], v[98:99]
    v_pk_add_f32 v[100:101], v[100:101], v[102:103]
    v_pk_add_f32 v[104:105], v[104:105], v[106:107]
    v_pk_add_f32 v[108:109], v[108:109], v[110:111]
    v_pk_add_f32 v[96:97], v[96:97], v[100:101]
    v_pk_add_f32 v[104:105], v[104:105], v[108:109]
    v_pk_add_f32 v[96:97], v[96:97], v[104:105]
    v_cvt_pk_bf16_f32 v12, v96, v97
    v_lshlrev_b32 v96, 16, v12
    v_and_b32 v97, 0xffff0000, v12
    v_pk_mul_f32 v[96:97], v[176:177], v[96:97]
    v_cvt_pk_bf16_f32 v12, v96, v97
    v_lshlrev_b32 v96, 16, v12
    v_and_b32 v97, 0xffff0000, v12
    v_pk_add_f32 v[96:97], v[180:181], v[96:97]
    v_cvt_pk_bf16_f32 v12, v96, v97
    v_lshlrev_b32 v96, 16, v12
    v_and_b32 v97, 0xffff0000, v12
    v_pk_mul_f32 v[98:99], v[96:97], v[178:179]
    v_cvt_pk_bf16_f32 v100, v98, v99
    v_add_f32 v12, v96, v97
    v_mul_f32 v13, v96, v96
    v_mov_b32_dpp v101, v100 row_ror:12 row_mask:0xf bank_mask:0xf
    v_mov_b32_dpp v102, v100 row_ror:8 row_mask:0xf bank_mask:0xf
    v_mov_b32_dpp v103, v100 row_ror:4 row_mask:0xf bank_mask:0xf
    v_fmac_f32 v13, v97, v97
    v_mov_b32_dpp v100, v100 row_ror:4 row_mask:0xf bank_mask:0x2
    v_mov_b32_dpp v101, v101 row_ror:4 row_mask:0xf bank_mask:0x2
    v_mov_b32_dpp v102, v102 row_ror:4 row_mask:0xf bank_mask:0x2
    v_mov_b32_dpp v103, v103 row_ror:4 row_mask:0xf bank_mask:0x2
    s_nop 1
    v_mfma_f32_16x16x32_bf16 v[24:27], v[100:103], v[168:171], 0
    v_mfma_f32_16x16x32_bf16 v[28:31], v[100:103], v[172:175], 0
    v_add_f32_dpp v12, v12, v12 row_ror:4 row_mask:0xf bank_mask:0xf
    v_add_f32_dpp v13, v13, v13 row_ror:4 row_mask:0xf bank_mask:0xf
    s_nop 0
    v_add_f32_dpp v12, v12, v12 row_ror:8 row_mask:0xf bank_mask:0xf
    v_add_f32_dpp v13, v13, v13 row_ror:8 row_mask:0xf bank_mask:0xf
    v_mov_b32 v14, v12
    v_mov_b32 v15, v13
    s_nop 0
    v_permlane16_swap_b32 v12, v14
    v_permlane16_swap_b32 v13, v15
    v_add_f32 v12, v12, v14
    v_add_f32 v13, v13, v15
    v_mov_b32 v14, v12
    v_mov_b32 v15, v13
    s_nop 0
    v_permlane32_swap_b32 v12, v14
    v_permlane32_swap_b32 v13, v15
    v_add_f32 v12, v12, v14
    v_add_f32 v13, v13, v15
    v_cndmask_b32 v24, v24, v28, s[76:77]
    v_cndmask_b32 v25, v25, v29, s[76:77]
    v_cndmask_b32 v26, v26, v30, s[76:77]
    v_cndmask_b32 v27, v27, v31, s[76:77]
    v_perm_b32 v24, v24, v27, s94
    v_perm_b32 v25, v25, v27, s95
    v_perm_b32 v26, v26, v27, s96
    v_mov_b32 v27, s85
    v_cndmask_b32 v24, v24, v12, s[92:93]
    v_cndmask_b32 v25, v25, v13, s[92:93]
    s_mov_b32 exec_lo, 0xffffffff
    s_mov_b32 exec_hi, 0xf
    buffer_store_dwordx4 v[24:27], v192, s[52:55], 0 offen sc1
    s_mov_b64 exec, -1
    s_cmp_ge_u32 s2, 144
    s_cbranch_scc1 L_s2
    s_cmp_ge_u32 s2, 80
    s_cbranch_scc1 L_end
    v_add_u32 v19, 160256, v18
    ds_write_b64 v19, v[96:97]
    v_and_b32 v6, 7, v1
    v_bfe_u32 v7, v1, 3, 2
    v_lshlrev_b32 v9, 7, v7
    v_lshl_add_u32 v9, v6, 2, v9
    s_lshl_b32 s8, s99, 5
    v_add_u32 v9, s8, v9
    v_add_u32 v10, 160256, v9
    v_add_u32 v9, 159232, v9
    s_waitcnt lgkmcnt(0)
    ds_read_b32 v40, v10
    ds_read_b32 v41, v9
    s_lshl_b32 s9, s100, 2
    s_add_u32 s9, s9, s99
    s_mul_i32 s11, s9, 12288
    s_mul_i32 s12, s3, 1536
    s_add_u32 s11, s11, s12
    s_add_u32 s11, s11, 4980736
    v_mul_u32_u24 v9, 1280, v7
    v_lshl_add_u32 v9, v6, 1, v9
    s_lshl_b32 s13, s9, 4
    v_and_b32 v14, 31, v1
    v_lshlrev_b32 v14, 4, v14
    v_lshlrev_b32 v15, 7, v5
    v_lshl_add_u32 v15, v6, 4, v15
    s_lshl_b32 s12, s3, 9
    s_add_u32 s12, s12, 135168
    v_add_u32 v15, s12, v15
    v_lshlrev_b32 v16, 4, v6
    v_lshl_add_u32 v16, v7, 2, v16
    v_lshrrev_b32 v17, 5, v1
    v_lshl_add_u32 v16, v17, 11, v16
    v_add_u32 v16, 135168, v16
    s_lshl_b32 s10, s9, 9
    s_lshl_b32 s12, s3, 6
    s_add_u32 s10, s10, s12
    s_add_u32 s10, s10, 6029312
    s_mov_b32 s56, s38
    s_mov_b32 s57, s39
    s_mov_b32 s58, 5120
    s_mov_b32 s59, 0x20000
    s_sleep 18
    s_waitcnt lgkmcnt(0)
    s_add_u32 s14, s42, s10
    s_addc_u32 s15, s43, 0
L_e_sp0:
    s_load_dwordx16 s[16:31], s[14:15], 0 glc
    s_waitcnt lgkmcnt(0)
    s_and_b64 vcc, s[16:17], s[18:19]
    s_or_b64 s[16:17], s[16:17], s[18:19]
    s_and_b64 vcc, vcc, s[20:21]
    s_or_b64 s[16:17], s[16:17], s[20:21]
    s_and_b64 vcc, vcc, s[22:23]
    s_or_b64 s[16:17], s[16:17], s[22:23]
    s_and_b64 vcc, vcc, s[24:25]
    s_or_b64 s[16:17], s[16:17], s[24:25]
    s_and_b64 vcc, vcc, s[26:27]
    s_or_b64 s[16:17], s[16:17], s[26:27]
    s_and_b32 vcc_lo, vcc_lo, vcc_hi
    s_or_b32 s16, s16, s17
    s_xor_b32 vcc_lo, vcc_lo, s85
    s_xor_b32 s16, s16, s85
    s_or_b32 s16, s16, vcc_lo
    s_cmp_eq_u32 s16, 0
    s_cbranch_scc1 L_e_sp0_ok
    s_sub_u32 s84, s84, 1
    s_cmp_lg_u32 s84, 0
    s_cbranch_scc1 L_e_sp0
L_e_sp0_ok:
L_e_poll:
    buffer_load_dwordx4 v[64:67], v8, s[52:55], s11 offen sc1
    buffer_load_dwordx4 v[68:71], v14, s[52:55], s11 offen offset:1024 sc1
    s_waitcnt vmcnt(0)
    v_xor_b32 v11, s85, v67
    v_xor_b32 v12, s85, v71
    v_or_b32 v11, v11, v12
    v_cmp_ne_u32 vcc, 0, v11
    s_cbranch_vccz L_ok_61
    s_sub_u32 s84, s84, 1
    s_cmp_lg_u32 s84, 0
    s_cbranch_scc1 L_e_poll
L_ok_61:
    v_perm_b32 v67, v64, v65, s97
    v_perm_b32 v67, v67, v66, s98
    v_perm_b32 v71, v68, v69, s97
    v_perm_b32 v71, v71, v70, s98
    s_mov_b32 exec_lo, 0xffffffff
    s_mov_b32 exec_hi, 0x0
    v_add_f32 v64, v64, v68
    v_add_f32 v65, v65, v69
    v_add_f32 v66, v66, v70
    v_add_f32 v67, v67, v71
    s_mov_b64 exec, -1
    v_add_f32_dpp v64, v64, v64 row_ror:8 row_mask:0xf bank_mask:0xf
    v_add_f32_dpp v65, v65, v65 row_ror:8 row_mask:0xf bank_mask:0xf
    v_add_f32_dpp v66, v66, v66 row_ror:8 row_mask:0xf bank_mask:0xf
    v_add_f32_dpp v67, v67, v67 row_ror:8 row_mask:0xf bank_mask:0xf
    ds_write_b128 v15, v[64:67]
    s_waitcnt lgkmcnt(0)
    s_barrier
    s_cmp_eq_u32 s3, 0
    s_cbranch_scc0 L_end
    ds_read_b32 v64, v16 offset:0
    ds_read_b32 v65, v16 offset:128
    ds_read_b32 v66, v16 offset:256
    ds_read_b32 v67, v16 offset:384
    ds_read_b32 v68, v16 offset:512
    ds_read_b32 v69, v16 offset:640
    ds_read_b32 v70, v16 offset:768
    ds_read_b32 v71, v16 offset:896
    ds_read_b32 v72, v16 offset:1024
    ds_read_b32 v73, v16 offset:1152
    ds_read_b32 v74, v16 offset:1280
    ds_read_b32 v75, v16 offset:1408
    ds_read_b32 v76, v16 offset:1536
    ds_read_b32 v77, v16 offset:1664
    ds_read_b32 v78, v16 offset:1792
    ds_read_b32 v79, v16 offset:1920
    s_waitcnt lgkmcnt(0)
    v_add_f32 v64, v64, v72
    v_add_f32 v65, v65, v73
    v_add_f32 v66, v66, v74
    v_add_f32 v67, v67, v75
    v_add_f32 v68, v68, v76
    v_add_f32 v69, v69, v77
    v_add_f32 v70, v70, v78
    v_add_f32 v71, v71, v79
    v_add_f32 v64, v64, v68
    v_add_f32 v65, v65, v69
    v_add_f32 v66, v66, v70
    v_add_f32 v67, v67, v71
    v_add_f32 v64, v64, v66
    v_add_f32 v65, v65, v67
    v_add_f32 v64, v64, v65
    v_mov_b32 v13, v64
    s_nop 1
    v_permlane32_swap_b32 v13, v64
    v_add_f32 v13, v13, v64
    v_cvt_pk_bf16_f32 v13, v13, v13
    v_and_b32 v13, 0xffff0000, v13
    s_waitcnt lgkmcnt(0)
    v_mul_f32 v13, v41, v13
    v_cvt_pk_bf16_f32 v13, v13, v13
    v_and_b32 v13, 0xffff0000, v13
    v_add_f32 v13, v40, v13
    v_cvt_pk_bf16_f32 v13, v13, v13
    s_mov_b32 exec_lo, 0xffffffff
    s_mov_b32 exec_hi, 0x0
    buffer_store_short v13, v9, s[56:59], s13 offen
    s_mov_b64 exec, -1
    s_cmp_eq_u32 s2, 0
    s_cbranch_scc0 L_end
    v_mov_b32 v8, s85
    s_mov_b32 exec_lo, 0x1
    s_mov_b32 exec_hi, 0x0
    buffer_store_dword v8, v1, s[52:55], 0 offen sc1
    s_mov_b64 exec, -1
    s_branch L_end
L_s2:
    s_sub_u32 s8, s2, 144
    s_mul_i32 s9, s8, 20
    v_lshl_add_u32 v17, v5, 2, v6
    v_mul_u32_u24 v17, 1280, v17
    v_lshl_add_u32 v17, v7, 3, v17
    s_mul_i32 s11, s3, 160
    s_add_u32 s11, s11, 53248
    v_add_u32 v17, s11, v17
    s_cmp_ge_u32 s3, 6
    s_cbranch_scc1 L_s2_w13
    s_waitcnt vmcnt(1)
L_s2_w13:
    s_waitcnt vmcnt(11)
    s_barrier
    ds_read_b64_tr_b16 v[84:85], v17
    ds_read_b64_tr_b16 v[86:87], v17 offset:32
    ds_read_b64_tr_b16 v[88:89], v17 offset:64
    ds_read_b64_tr_b16 v[90:91], v17 offset:96
    ds_read_b64_tr_b16 v[92:93], v17 offset:128
    v_lshlrev_b32 v12, 2, v1
    v_add_u32 v12, 147456, v12
    v_and_b32 v18, 3, v1
    v_lshlrev_b32 v18, 3, v18
    v_add_u32 v18, 156288, v18
    v_lshrrev_b32 v13, 3, v4
    v_mul_u32_u24 v13, 12288, v13
    v_and_b32 v14, 7, v4
    v_lshl_add_u32 v13, v14, 4, v13
    v_mul_u32_u24 v14, 24576, v5
    v_add_u32 v94, v13, v14
    s_mul_i32 s33, s3, 122880
    s_lshl_b32 s13, s8, 7
    s_add_u32 s33, s33, s13
    s_add_u32 s33, s33, 4980736
    s_mul_i32 s13, s8, 43
    s_lshr_b32 s13, s13, 9
    s_mul_i32 s32, s13, 16
    s_lshl_b32 s13, s8, 2
    s_add_u32 s32, s32, s13
    s_mul_i32 s13, s3, 5120
    s_add_u32 s32, s32, s13
    s_add_u32 s32, s32, 6029312
    v_lshlrev_b32 v16, 9, v1
    s_cmp_ge_u32 s3, 6
    s_cbranch_scc1 L_s2_static
    s_cmp_eq_u32 s3, 5
    s_cbranch_scc1 L_s2_stats
    s_lshl_b32 s10, s3, 2
    s_add_u32 s10, s10, s9
    s_lshl_b32 s10, s10, 9
    s_add_u32 s10, s10, 1851392
    s_lshl_b32 s11, s3, 9
    s_add_u32 s11, s11, 147456
    v_add_u32 v9, s11, v8
    s_sleep 4
L_s2_poll:
    buffer_load_dwordx4 v[96:99], v8, s[52:55], s10 offen sc1
    buffer_load_dwordx4 v[100:103], v8, s[52:55], s10 offen offset:1024 sc1
    s_waitcnt vmcnt(0)
    v_xor_b32 v10, s85, v99
    v_xor_b32 v11, s85, v103
    v_or_b32 v10, v10, v11
    v_cmp_ne_u32 vcc, 0, v10
    s_cbranch_vccz L_ok_62
    s_sub_u32 s84, s84, 1
    s_cmp_lg_u32 s84, 0
    s_cbranch_scc1 L_s2_poll
L_ok_62:
    v_perm_b32 v99, v96, v97, s97
    v_perm_b32 v99, v99, v98, s98
    v_perm_b32 v103, v100, v101, s97
    v_perm_b32 v103, v103, v102, s98
    v_add_f32 v96, v96, v100
    v_add_f32 v97, v97, v101
    v_add_f32 v98, v98, v102
    v_add_f32 v99, v99, v103
    v_mov_b32 v100, v96
    v_mov_b32 v101, v97
    v_mov_b32 v102, v98
    v_mov_b32 v103, v99
    v_permlane32_swap_b32 v96, v100
    v_permlane32_swap_b32 v97, v101
    v_permlane32_swap_b32 v98, v102
    v_permlane32_swap_b32 v99, v103
    v_add_f32 v96, v96, v100
    v_add_f32 v97, v97, v101
    v_add_f32 v98, v98, v102
    v_add_f32 v99, v99, v103
    s_mov_b32 exec_lo, 0xffffffff
    s_mov_b32 exec_hi, 0x0
    ds_write_b128 v9, v[96:99]
    s_mov_b64 exec, -1
    s_branch L_s2_b4
L_s2_static:
    s_sub_u32 s10, s3, 6
    s_lshl_b32 s10, s10, 10
    s_add_u32 s10, s10, 150016
    v_add_u32 v9, s10, v8
    s_branch L_s2_schk
L_s2_spoll:
    s_mov_b32 s12, s26
    buffer_load_dwordx4 v[128:131], v8, s[52:55], s12 offen offset:0 sc1
    buffer_load_dwordx4 v[132:135], v8, s[52:55], s12 offen offset:1024 sc1
    buffer_load_dwordx4 v[136:139], v8, s[52:55], s12 offen offset:2048 sc1
    buffer_load_dwordx4 v[140:143], v8, s[52:55], s12 offen offset:3072 sc1
    s_add_u32 s12, s12, 4096
    buffer_load_dwordx4 v[144:147], v8, s[52:55], s12 offen offset:0 sc1
    buffer_load_dwordx4 v[148:151], v8, s[52:55], s12 offen offset:1024 sc1
    buffer_load_dwordx4 v[152:155], v8, s[52:55], s12 offen offset:2048 sc1
    buffer_load_dwordx4 v[156:159], v8, s[52:55], s12 offen offset:3072 sc1
    s_add_u32 s12, s12, 4096
    buffer_load_dwordx4 v[160:163], v8, s[52:55], s12 offen offset:0 sc1
    buffer_load_dwordx4 v[164:167], v8, s[52:55], s12 offen offset:1024 sc1
L_s2_schk:
    s_waitcnt vmcnt(0)
    v_xor_b32 v10, s85, v131
    v_xor_b32 v11, s85, v135
    v_or_b32 v10, v10, v11
    v_xor_b32 v11, s85, v139
    v_or_b32 v10, v10, v11
    v_xor_b32 v11, s85, v143
    v_or_b32 v10, v10, v11
    v_xor_b32 v11, s85, v147
    v_or_b32 v10, v10, v11
    v_xor_b32 v11, s85, v151
    v_or_b32 v10, v10, v11
    v_xor_b32 v11, s85, v155
    v_or_b32 v10, v10, v11
    v_xor_b32 v11, s85, v159
    v_or_b32 v10, v10, v11
    v_xor_b32 v11, s85, v163
    v_or_b32 v10, v10, v11
    v_xor_b32 v11, s85, v167
    v_or_b32 v10, v10, v11
    v_cmp_ne_u32 vcc, 0, v10
    s_cbranch_vccz L_ok_63
    s_sleep 1
    s_sub_u32 s84, s84, 1
    s_cmp_lg_u32 s84, 0
    s_cbranch_scc1 L_s2_spoll
L_ok_63:
    v_perm_b32 v131, v128, v129, s97
    v_perm_b32 v131, v131, v130, s98
    v_perm_b32 v135, v132, v133, s97
    v_perm_b32 v135, v135, v134, s98
    v_perm_b32 v139, v136, v137, s97
    v_perm_b32 v139, v139, v138, s98
    v_perm_b32 v143, v140, v141, s97
    v_perm_b32 v143, v143, v142, s98
    v_perm_b32 v147, v144, v145, s97
    v_perm_b32 v147, v147, v146, s98
    v_perm_b32 v151, v148, v149, s97
    v_perm_b32 v151, v151, v150, s98
    v_perm_b32 v155, v152, v153, s97
    v_perm_b32 v155, v155, v154, s98
    v_perm_b32 v159, v156, v157, s97
    v_perm_b32 v159, v159, v158, s98
    v_perm_b32 v163, v160, v161, s97
    v_perm_b32 v163, v163, v162, s98
    v_perm_b32 v167, v164, v165, s97
    v_perm_b32 v167, v167, v166, s98
    v_add_f32 v128, v128, v132
    v_add_f32 v129, v129, v133
    v_add_f32 v130, v130, v134
    v_add_f32 v131, v131, v135
    v_add_f32 v128, v128, v136
    v_add_f32 v129, v129, v137
    v_add_f32 v130, v130, v138
    v_add_f32 v131, v131, v139
    v_add_f32 v128, v128, v140
    v_add_f32 v129, v129, v141
    v_add_f32 v130, v130, v142
    v_add_f32 v131, v131, v143
    v_add_f32 v128, v128, v144
    v_add_f32 v129, v129, v145
    v_add_f32 v130, v130, v146
    v_add_f32 v131, v131, v147
    v_add_f32 v128, v128, v148
    v_add_f32 v129, v129, v149
    v_add_f32 v130, v130, v150
    v_add_f32 v131, v131, v151
    v_add_f32 v128, v128, v152
    v_add_f32 v129, v129, v153
    v_add_f32 v130, v130, v154
    v_add_f32 v131, v131, v155
    v_add_f32 v128, v128, v156
    v_add_f32 v129, v129, v157
    v_add_f32 v130, v130, v158
    v_add_f32 v131, v131, v159
    v_add_f32 v128, v128, v160
    v_add_f32 v129, v129, v161
    v_add_f32 v130, v130, v162
    v_add_f32 v131, v131, v163
    v_add_f32 v128, v128, v164
    v_add_f32 v129, v129, v165
    v_add_f32 v130, v130, v166
    v_add_f32 v131, v131, v167
    ds_write_b128 v9, v[128:131]
    s_branch L_s2_b4
L_s2_stats:
    s_lshl_b32 s11, s9, 6
    s_add_u32 s11, s11, 2834432
    v_and_b32 v9, 15, v1
    v_lshlrev_b32 v9, 4, v9
    s_sleep 4
    s_mov_b32 s16, 0xffff0000
    s_mov_b32 s17, -1
L_s2_tpoll:
    buffer_load_dwordx4 v[96:99], v8, s[52:55], s11 offen sc1
    buffer_load_dwordx4 v[100:103], v9, s[52:55], s11 offen offset:1024 sc1
    s_waitcnt vmcnt(0)
    v_xor_b32 v10, s85, v99
    v_xor_b32 v11, s85, v103
    v_or_b32 v10, v10, v11
    v_cmp_ne_u32 vcc, 0, v10
    s_cbranch_vccz L_ok_64
    s_sub_u32 s84, s84, 1
    s_cmp_lg_u32 s84, 0
    s_cbranch_scc1 L_s2_tpoll
L_ok_64:
    v_cndmask_b32 v14, v100, 0, s[16:17]
    v_cndmask_b32 v15, v101, 0, s[16:17]
    v_add_f32 v14, v14, v96
    v_add_f32 v15, v15, v97
    s_nop 0
    v_add_f32_dpp v14, v14, v14 row_ror:4 row_mask:0xf bank_mask:0xf
    v_add_f32_dpp v15, v15, v15 row_ror:4 row_mask:0xf bank_mask:0xf
    s_nop 0
    v_add_f32_dpp v14, v14, v14 row_ror:8 row_mask:0xf bank_mask:0xf
    v_add_f32_dpp v15, v15, v15 row_ror:8 row_mask:0xf bank_mask:0xf
    v_mov_b32 v98, v14
    v_mov_b32 v99, v15
    s_nop 0
    v_permlane16_swap_b32 v14, v98
    v_permlane16_swap_b32 v15, v99
    v_add_f32 v14, v14, v98
    v_add_f32 v15, v15, v99
    v_mov_b32 v98, v14
    v_mov_b32 v99, v15
    s_nop 0
    v_permlane32_swap_b32 v14, v98
    v_permlane32_swap_b32 v15, v99
    v_add_f32 v14, v14, v98
    v_add_f32 v15, v15, v99
    v_mul_f32 v14, 0x3acccccd, v14
    v_mul_f32 v15, 0x3acccccd, v15
    v_fma_f32 v15, -v14, v14, v15
    v_max_f32 v15, 0, v15
    v_cvt_pk_bf16_f32 v19, v14, v15
    v_lshlrev_b32 v14, 16, v19
    v_and_b32 v15, 0xffff0000, v19
    v_add_f32 v15, 0x3727c5ac, v15
    v_cvt_pk_bf16_f32 v15, v15, v15
    v_and_b32 v15, 0xffff0000, v15
    v_sqrt_f32 v15, v15
    s_nop 0
    v_cvt_pk_bf16_f32 v15, v15, v15
    v_and_b32 v15, 0xffff0000, v15
    v_rcp_f32 v15, v15
    s_nop 0
    ds_write_b64 v18, v[14:15]
L_s2_b4:
    v_mov_b32 v19, s85
    s_waitcnt lgkmcnt(0)
    s_barrier
    s_mov_b32 exec_lo, 0x3ff
    s_mov_b32 exec_hi, 0x0
    buffer_store_dword v19, v16, s[52:55], s32 offen sc1
    s_mov_b64 exec, -1
    ds_read_b32 v24, v12 offset:0
    ds_read_b32 v32, v12 offset:256
    ds_read_b32 v25, v12 offset:512
    ds_read_b32 v33, v12 offset:768
    ds_read_b32 v26, v12 offset:1024
    ds_read_b32 v34, v12 offset:1280
    ds_read_b32 v27, v12 offset:1536
    ds_read_b32 v35, v12 offset:1792
    ds_read_b32 v28, v12 offset:2048
    ds_read_b32 v36, v12 offset:2304
    ds_read_b32 v40, v12 offset:2560
    ds_read_b32 v41, v12 offset:2816
    ds_read_b32 v42, v12 offset:3072
    ds_read_b32 v43, v12 offset:3328
    ds_read_b32 v44, v12 offset:3584
    s_waitcnt lgkmcnt(5)
    ds_read_b32 v45, v12 offset:3840
    ds_read_b32 v46, v12 offset:4096
    ds_read_b32 v47, v12 offset:4352
    ds_read_b64 v[14:15], v18
    v_add_f32 v24, v24, v25
    v_add_f32 v26, v26, v27
    v_add_f32 v32, v32, v33
    v_add_f32 v34, v34, v35
    v_add_f32 v24, v24, v26
    v_add_f32 v32, v32, v34
    v_add_f32 v24, v24, v28
    v_add_f32 v32, v32, v36
    s_waitcnt lgkmcnt(0)
    v_add_f32 v40, v40, v44
    v_add_f32 v41, v41, v45
    v_add_f32 v42, v42, v46
    v_add_f32 v43, v43, v47
    v_fma_f32 v24, -v14, v40, v24
    v_fma_f32 v32, -v14, v42, v32
    v_fma_f32 v24, v24, v15, v41
    v_fma_f32 v32, v32, v15, v43
    v_cvt_pk_bf16_f32 v19, v24, v32
    v_lshlrev_b32 v24, 16, v19
    v_and_b32 v32, 0xffff0000, v19
    v_cmp_lt_f32 vcc, 0, v24
    s_nop 1
    v_cndmask_b32 v25, 0, 1.0, vcc
    v_mul_f32 v24, v24, v25
    v_mul_f32 v24, v24, v32
    s_nop 1
    v_mov_b32_dpp v25, v24 row_ror:12 row_mask:0xf bank_mask:0xf
    v_mov_b32_dpp v26, v24 row_ror:8 row_mask:0xf bank_mask:0xf
    v_mov_b32_dpp v27, v24 row_ror:4 row_mask:0xf bank_mask:0xf
    v_cvt_pk_bf16_f32 v28, v24, v25
    v_cvt_pk_bf16_f32 v29, v26, v27
    s_add_u32 s13, s33, 98304
    s_nop 0
    v_mov_b32_dpp v28, v28 row_ror:4 row_mask:0xf bank_mask:0x2
    v_mov_b32_dpp v29, v29 row_ror:4 row_mask:0xf bank_mask:0x2
    s_nop 0
    v_mov_b32_dpp v28, v28 row_ror:8 row_mask:0xf bank_mask:0xc
    v_mov_b32_dpp v29, v29 row_ror:8 row_mask:0xf bank_mask:0xc
    s_nop 1
    v_mfma_f32_16x16x16_bf16 v[32:35], v[28:29], v[84:85], 0
    v_mfma_f32_16x16x16_bf16 v[36:39], v[28:29], v[86:87], 0
    v_mfma_f32_16x16x16_bf16 v[40:43], v[28:29], v[88:89], 0
    v_mfma_f32_16x16x16_bf16 v[44:47], v[28:29], v[90:91], 0
    v_mfma_f32_16x16x16_bf16 v[48:51], v[28:29], v[92:93], 0
    s_nop 4
    v_cndmask_b32 v32, v32, v36, s[76:77]
    v_cndmask_b32 v32, v32, v40, s[78:79]
    v_cndmask_b32 v32, v32, v44, s[80:81]
    v_cndmask_b32 v33, v33, v37, s[76:77]
    v_cndmask_b32 v33, v33, v41, s[78:79]
    v_cndmask_b32 v33, v33, v45, s[80:81]
    v_cndmask_b32 v34, v34, v38, s[76:77]
    v_cndmask_b32 v34, v34, v42, s[78:79]
    v_cndmask_b32 v34, v34, v46, s[80:81]
    v_cndmask_b32 v35, v35, v39, s[76:77]
    v_cndmask_b32 v35, v35, v43, s[78:79]
    v_cndmask_b32 v35, v35, v47, s[80:81]
    v_perm_b32 v32, v32, v35, s94
    v_perm_b32 v33, v33, v35, s95
    v_perm_b32 v34, v34, v35, s96
    v_mov_b32 v35, s85
    buffer_store_dwordx4 v[32:35], v94, s[52:55], s33 offen sc1
    v_perm_b32 v48, v48, v51, s94
    v_perm_b32 v49, v49, v51, s95
    v_perm_b32 v50, v50, v51, s96
    v_mov_b32 v51, s85
    s_mov_b32 exec_lo, 0xffff
    s_mov_b32 exec_hi, 0x0
    buffer_store_dwordx4 v[48:51], v13, s[52:55], s13 offen sc1
    s_mov_b64 exec, -1
L_end:
L_exit:
    s_endpgm
.section .rodata,"a"
.p2align 6
.amdhsa_kernel adaLN_cond__sliding_block_cached__glu_gated_reglu__decode_kernel
  .amdhsa_next_free_vgpr 256
  .amdhsa_next_free_sgpr 102
  .amdhsa_accum_offset 256
  .amdhsa_group_segment_fixed_size 0
  .amdhsa_kernarg_size 112
  .amdhsa_user_sgpr_count 2
  .amdhsa_user_sgpr_kernarg_segment_ptr 1
  .amdhsa_system_sgpr_workgroup_id_x 1
.end_amdhsa_kernel
```
